```python
import torch

def _softmax(x, axis=-1):
    return torch.softmax(x, dim=axis)
def _gelu(x):
    return torch.nn.functional.gelu(x, approximate="tanh")
def _silu(x):
    return torch.nn.functional.silu(x)
def _sigmoid(x):
    return torch.sigmoid(x)
def _layernorm(x, axis=-1, eps=1e-5):
    m = x.mean(dim=axis, keepdim=True)
    v = x.var(dim=axis, keepdim=True, unbiased=False)
    return (x - m) / torch.sqrt(v + eps)
def _scatter_add(tgt, idx, src, axis=0):
    return tgt.clone().index_add_(axis, idx, src)
def _segment_sum(src, seg, n):
    out = torch.zeros((n,) + src.shape[1:], dtype=src.dtype)
    return out.index_add_(0, seg, src)
def _pad(x, pw):
    flat = tuple(v for pair in reversed(pw) for v in pair)
    return torch.nn.functional.pad(x, flat)

kernel_name = 'sequential_preLN__gqa_block_cached__glu_gated_reglu__decode'

def setup_inputs():

    _w = (lambda a: (lambda t: t.to(torch.bfloat16) if t.is_floating_point() else t)(torch.as_tensor(a)))
    def _A_setup():
        B, Sq, D = 2, 1, 512
        Hq, Hkv, Sk, Dh = 32, 32, 8192, 128
        assert Hq % Hkv == 0, (Hq, Hkv)
        return {
            "x": _w((lambda *s: torch.randn(*s, dtype=torch.bfloat16) * 0.05)(B, Sq, D)),
            "k_cache": _w((lambda *s: torch.randn(*s, dtype=torch.bfloat16) * 1.6)(B, Hkv, Sk, Dh)),
            "v_cache": _w((lambda *s: torch.randn(*s, dtype=torch.bfloat16) * 0.8)(B, Hkv, Sk, Dh)),
            "wq": _w((lambda *s: torch.randn(*s, dtype=torch.bfloat16) * 1.6)(D, Hq * Dh) * (D ** -0.5)),
            "wo": _w((lambda *s: torch.randn(*s, dtype=torch.bfloat16) * 0.8)(Hq * Dh, D) * ((Hq * Dh) ** -0.5)),
        }
    _A_in = _A_setup()

    def _B_setup():
        B, S, D, F = 2, 1, 512, 1376
        return {
            "x": _w((lambda *s: torch.randn(*s, dtype=torch.bfloat16) * 0.05)(B, S, D)),
            "W_gate": _w((lambda *s: torch.randn(*s, dtype=torch.bfloat16) * 0.4)(D, F) * (2.0 / D) ** 0.5),
            "W_up": _w((lambda *s: torch.randn(*s, dtype=torch.bfloat16) * 0.4)(D, F) * (2.0 / D) ** 0.5),
            "W_down": _w((lambda *s: torch.randn(*s, dtype=torch.bfloat16) * 0.4)(F, D) * (1.0 / F) ** 0.5),
        }
    _B_in = _B_setup()

    return {
        "A_x": _A_in["x"],
        "A_k_cache": _A_in["k_cache"],
        "A_v_cache": _A_in["v_cache"],
        "A_wq": _A_in["wq"],
        "A_wo": _A_in["wo"],
        "B_x": _B_in["x"],
        "B_W_gate": _B_in["W_gate"],
        "B_W_up": _B_in["W_up"],
        "B_W_down": _B_in["W_down"],
    }

def reference(A_x, A_k_cache, A_v_cache, A_wq, A_wo, B_x, B_W_gate, B_W_up, B_W_down):
    def _A_ref(x, k_cache, v_cache, wq, wo):
        B, Sq, D = x.shape
        Hq, Dh = 32, 128
        Hkv = k_cache.shape[1]
        rep = Hq // Hkv
        q = (lambda x, *d: x.permute(*d))((x @ wq).reshape(B, Sq, Hq, Dh), 0, 2, 1, 3)
        k = (lambda x, n, axis: torch.repeat_interleave(x, n, dim=axis))(k_cache, rep, axis=1)
        v = (lambda x, n, axis: torch.repeat_interleave(x, n, dim=axis))(v_cache, rep, axis=1)
        scores = torch.einsum("bhqd,bhkd->bhqk", q, k) * (Dh ** -0.5)
        p = _softmax(scores, axis=-1)
        o = torch.einsum("bhqk,bhkd->bhqd", p, v)
        return (lambda x, *d: x.permute(*d))(o, 0, 2, 1, 3).reshape(B, Sq, Hq * Dh) @ wo

    def _B_ref(x, W_gate, W_up, W_down):
        gate = torch.einsum("bsd,df->bsf", x, W_gate)
        up = torch.einsum("bsd,df->bsf", x, W_up)
        gate = gate * (lambda x, dt: x.to(dt))(gate > 0, gate.dtype)
        h = gate * up
        return torch.einsum("bsf,fd->bsd", h, W_down)

    x = A_x
    h = x + _A_ref(_layernorm(x, axis=-1), A_k_cache, A_v_cache, A_wq, A_wo)
    h2 = h + _B_ref(_layernorm(h, axis=-1), B_W_gate, B_W_up, B_W_down)
    return h2
```

```asm
; @launch grid=(256,1,1) block=(512,1,1) lds=14336
.amdgcn_target "amdgcn-amd-amdhsa--gfx950"
.text
.globl sequential_preLN__gqa_block_cached__glu_gated_reglu__decode_kernel
.p2align 8
.type sequential_preLN__gqa_block_cached__glu_gated_reglu__decode_kernel,@function
sequential_preLN__gqa_block_cached__glu_gated_reglu__decode_kernel:
    s_cmp_ge_u32 s2, 256
    s_cbranch_scc1 L_end
    s_load_dwordx16 s[4:19], s[0:1], 0
    s_load_dwordx8 s[20:27], s[0:1], 64
    v_lshrrev_b32 v1, 6, v0
    v_and_b32 v0, 63, v0
    v_readfirstlane_b32 s28, v1
    s_lshr_b32 s29, s2, 3
    s_and_b32 s30, s2, 7
    s_bfe_u32 s31, s2, 0x10001
    s_bfe_u32 s32, s2, 0x10002
    s_lshl_b32 s32, s32, 1
    s_and_b32 s34, s2, 1
    s_or_b32 s32, s32, s34
    s_and_b32 s34, s28, 3
    s_lshl_b32 s33, s31, 5
    s_add_u32 s33, s33, s29
    s_waitcnt lgkmcnt(0)
    s_mov_b32 s36, s26
    s_mov_b32 s37, s27
    s_mov_b32 s38, 3145728
    s_mov_b32 s39, 0x20000
    s_cmp_ge_u32 s28, 4
    s_cbranch_scc1 L_helper
    v_lshlrev_b32 v1, 4, v0
    s_lshl_b32 s52, s33, 21
    s_add_u32 s40, s6, s52
    s_addc_u32 s41, s7, 0
    s_mov_b32 s42, 0x200000
    s_mov_b32 s43, 0x20000
    s_add_u32 s44, s8, s52
    s_addc_u32 s45, s9, 0
    s_mov_b32 s46, 0x200000
    s_mov_b32 s47, 0x20000
    s_mov_b32 s48, s26
    s_mov_b32 s49, s27
    s_mov_b32 s50, 0
    s_mov_b32 s51, 0x20000
    s_lshl_b32 s60, s32, 2
    s_add_u32 s60, s60, s28
    s_mul_i32 s58, s33, 16
    s_lshl_b32 s61, s33, 8
    s_add_u32 s61, s61, 4096
    v_mov_b32 v33, 264
    s_add_u32 s52, s60, 0
    s_add_u32 s52, s52, s58
    s_and_b32 s52, s52, 511
    s_lshl_b32 s52, s52, 12
    buffer_load_dwordx4 v[100:103], v1, s[40:43], s52 offen offset:0 nt
    buffer_load_dwordx4 v[104:107], v1, s[40:43], s52 offen offset:1024 nt
    buffer_load_dwordx4 v[108:111], v1, s[40:43], s52 offen offset:2048 nt
    buffer_load_dwordx4 v[112:115], v1, s[40:43], s52 offen offset:3072 nt
    buffer_load_dwordx4 v[116:119], v1, s[44:47], s52 offen offset:0 nt
    buffer_load_dwordx4 v[120:123], v1, s[44:47], s52 offen offset:1024 nt
    buffer_load_dwordx4 v[124:127], v1, s[44:47], s52 offen offset:2048 nt
    buffer_load_dwordx4 v[128:131], v1, s[44:47], s52 offen offset:3072 nt
    s_add_u32 s52, s60, 16
    s_add_u32 s52, s52, s58
    s_and_b32 s52, s52, 511
    s_lshl_b32 s52, s52, 12
    buffer_load_dwordx4 v[132:135], v1, s[40:43], s52 offen offset:0 nt
    buffer_load_dwordx4 v[136:139], v1, s[40:43], s52 offen offset:1024 nt
    buffer_load_dwordx4 v[140:143], v1, s[40:43], s52 offen offset:2048 nt
    buffer_load_dwordx4 v[144:147], v1, s[40:43], s52 offen offset:3072 nt
    buffer_load_dwordx4 v[148:151], v1, s[44:47], s52 offen offset:0 nt
    buffer_load_dwordx4 v[152:155], v1, s[44:47], s52 offen offset:1024 nt
    buffer_load_dwordx4 v[156:159], v1, s[44:47], s52 offen offset:2048 nt
    buffer_load_dwordx4 v[160:163], v1, s[44:47], s52 offen offset:3072 nt
    s_add_u32 s52, s60, 32
    s_add_u32 s52, s52, s58
    s_and_b32 s52, s52, 511
    s_lshl_b32 s52, s52, 12
    buffer_load_dwordx4 v[164:167], v1, s[40:43], s52 offen offset:0 nt
    buffer_load_dwordx4 v[168:171], v1, s[40:43], s52 offen offset:1024 nt
    buffer_load_dwordx4 v[172:175], v1, s[40:43], s52 offen offset:2048 nt
    buffer_load_dwordx4 v[176:179], v1, s[40:43], s52 offen offset:3072 nt
    buffer_load_dwordx4 v[180:183], v1, s[44:47], s52 offen offset:0 nt
    buffer_load_dwordx4 v[184:187], v1, s[44:47], s52 offen offset:1024 nt
    buffer_load_dwordx4 v[188:191], v1, s[44:47], s52 offen offset:2048 nt
    buffer_load_dwordx4 v[192:195], v1, s[44:47], s52 offen offset:3072 nt
    s_add_u32 s52, s60, 48
    s_add_u32 s52, s52, s58
    s_and_b32 s52, s52, 511
    s_lshl_b32 s52, s52, 12
    buffer_load_dwordx4 v[196:199], v1, s[40:43], s52 offen offset:0 nt
    buffer_load_dwordx4 v[200:203], v1, s[40:43], s52 offen offset:1024 nt
    buffer_load_dwordx4 v[204:207], v1, s[40:43], s52 offen offset:2048 nt
    buffer_load_dwordx4 v[208:211], v1, s[40:43], s52 offen offset:3072 nt
    buffer_load_dwordx4 v[212:215], v1, s[44:47], s52 offen offset:0 nt
    buffer_load_dwordx4 v[216:219], v1, s[44:47], s52 offen offset:1024 nt
    buffer_load_dwordx4 v[220:223], v1, s[44:47], s52 offen offset:2048 nt
    buffer_load_dwordx4 v[224:227], v1, s[44:47], s52 offen offset:3072 nt
    s_add_u32 s52, s60, 64
    s_add_u32 s52, s52, s58
    s_and_b32 s52, s52, 511
    s_lshl_b32 s52, s52, 12
    s_mov_b32 s54, 6
    buffer_load_dwordx4 v[36:39], v1, s[40:43], s52 offen offset:0 nt
    buffer_load_dwordx4 v[40:43], v1, s[40:43], s52 offen offset:1024 nt
    s_waitcnt vmcnt(33)
    buffer_load_dwordx4 v[44:47], v1, s[40:43], s52 offen offset:2048 nt
    s_waitcnt vmcnt(33)
    buffer_load_dwordx4 v[48:51], v1, s[40:43], s52 offen offset:3072 nt
    s_waitcnt vmcnt(33)
    buffer_load_dwordx4 v[52:55], v1, s[44:47], s52 offen offset:0 nt
    s_waitcnt vmcnt(33)
    buffer_load_dwordx4 v[56:59], v1, s[44:47], s52 offen offset:1024 nt
    s_waitcnt vmcnt(33)
    buffer_load_dwordx4 v[60:63], v1, s[44:47], s52 offen offset:2048 nt
    s_waitcnt vmcnt(33)
    buffer_load_dwordx4 v[64:67], v1, s[44:47], s52 offen offset:3072 nt
    s_add_u32 s52, s60, 80
    s_add_u32 s52, s52, s58
    s_and_b32 s52, s52, 511
    s_lshl_b32 s52, s52, 12
    s_waitcnt vmcnt(33)
    buffer_load_dwordx4 v[68:71], v1, s[40:43], s52 offen offset:0 nt
    s_waitcnt vmcnt(33)
    buffer_load_dwordx4 v[72:75], v1, s[40:43], s52 offen offset:1024 nt
    s_waitcnt vmcnt(33)
    buffer_load_dwordx4 v[76:79], v1, s[40:43], s52 offen offset:2048 nt
    s_waitcnt vmcnt(33)
    buffer_load_dwordx4 v[80:83], v1, s[40:43], s52 offen offset:3072 nt
    s_waitcnt vmcnt(33)
    buffer_load_dwordx4 v[84:87], v1, s[44:47], s52 offen offset:0 nt
    s_waitcnt vmcnt(33)
    buffer_load_dwordx4 v[88:91], v1, s[44:47], s52 offen offset:1024 nt
    s_waitcnt vmcnt(33)
    buffer_load_dwordx4 v[92:95], v1, s[44:47], s52 offen offset:2048 nt
    s_waitcnt vmcnt(33)
    buffer_load_dwordx4 v[96:99], v1, s[44:47], s52 offen offset:3072 nt
    s_mov_b32 s53, 6
    s_mov_b32 s55, 1
    s_mov_b32 s56, 1
    s_mov_b32 s57, 0
    s_mov_b32 s63, 0
    v_mov_b32 v6, 0
    v_mov_b32 v7, 0
    v_mov_b32 v8, 0
    v_mov_b32 v9, 0
    v_mov_b32 v10, 0
    v_mov_b32 v11, 0
    v_mov_b32 v12, 0
    v_mov_b32 v13, 0
    v_mov_b32 v14, 0xf149f2ca
    v_mov_b32 v15, 0
    s_barrier
    v_and_b32 v23, 15, v0
    v_lshlrev_b32 v23, 4, v23
    ds_read_b128 v[2:5], v23 offset:0
    s_waitcnt lgkmcnt(0)
L_loop:
    s_cmp_eq_u32 s57, 2
    s_cbranch_scc1 L_park0
L_park0_ret:
    s_cmp_eq_u32 s57, 6
    s_cbranch_scc1 L_park1
L_park1_ret:
    s_cmp_eq_u32 s57, 10
    s_cbranch_scc1 L_park2
L_park2_ret:
    s_cmp_eq_u32 s57, 14
    s_cbranch_scc1 L_park3
L_park3_ret:
    s_cmp_eq_u32 s57, 16
    s_cbranch_scc1 L_go2
L_go2_ret:
    s_cmp_eq_u32 s57, 4
    s_cbranch_scc1 L_go
L_go_ret:
    s_cmp_eq_u32 s55, 0
    s_cbranch_scc1 L_fin
    s_lshl_b32 s70, s53, 4
    s_add_u32 s70, s70, s60
    s_add_u32 s71, s70, 16
    s_cmp_lt_u32 s53, 24
    s_cbranch_scc1 L_have
    v_mov_b32 v32, 2
    s_mov_b64 exec, 1
    ds_add_rtn_u32 v31, v33, v32
    s_mov_b64 exec, -1
    s_waitcnt lgkmcnt(0)
    v_readfirstlane_b32 s62, v31
    s_min_u32 s62, s62, 254
    s_lshl_b32 s62, s62, 2
    s_add_u32 s62, s62, 13312
    v_mov_b32 v32, s62
    s_mov_b32 s63, 262144
L_tq:
    ds_read2_b32 v[34:35], v32 offset0:0 offset1:1
    s_waitcnt lgkmcnt(0)
    v_readfirstlane_b32 s71, v35
    v_readfirstlane_b32 s70, v34
    s_cmp_lg_u32 s71, -1
    s_cbranch_scc1 L_have
    s_sleep 1
    s_sub_u32 s63, s63, 1
    s_cbranch_scc0 L_tq
L_have:
    s_mov_b32 s52, s70
    s_add_u32 s53, s53, 1
    s_cmp_lt_u32 s52, 512
    s_cselect_b32 s42, 0x200000, 0
    s_cselect_b32 s46, 0x200000, 0
    s_cselect_b32 s55, 1, 0
    s_add_u32 s52, s52, s58
    s_and_b32 s52, s52, 511
    s_lshl_b32 s52, s52, 12
    s_waitcnt vmcnt(15)
    v_dot2_f32_bf16 v16, v36, v2, 0
    v_dot2_f32_bf16 v16, v37, v3, v16
    v_dot2_f32_bf16 v16, v38, v4, v16
    v_dot2_f32_bf16 v16, v39, v5, v16
    buffer_load_dwordx4 v[36:39], v1, s[40:43], s52 offen offset:0 nt
    s_waitcnt vmcnt(15)
    v_dot2_f32_bf16 v17, v40, v2, 0
    v_dot2_f32_bf16 v17, v41, v3, v17
    v_dot2_f32_bf16 v17, v42, v4, v17
    v_dot2_f32_bf16 v17, v43, v5, v17
    buffer_load_dwordx4 v[40:43], v1, s[40:43], s52 offen offset:1024 nt
    s_waitcnt vmcnt(15)
    v_dot2_f32_bf16 v18, v44, v2, 0
    v_dot2_f32_bf16 v18, v45, v3, v18
    v_dot2_f32_bf16 v18, v46, v4, v18
    v_dot2_f32_bf16 v18, v47, v5, v18
    buffer_load_dwordx4 v[44:47], v1, s[40:43], s52 offen offset:2048 nt
    s_waitcnt vmcnt(15)
    v_dot2_f32_bf16 v19, v48, v2, 0
    v_dot2_f32_bf16 v19, v49, v3, v19
    v_dot2_f32_bf16 v19, v50, v4, v19
    v_dot2_f32_bf16 v19, v51, v5, v19
    buffer_load_dwordx4 v[48:51], v1, s[40:43], s52 offen offset:3072 nt
    v_add_f32_dpp v20, v16, v16 row_ror:8 row_mask:0xf bank_mask:0x3
    v_add_f32_dpp v20, v18, v18 row_ror:8 row_mask:0xf bank_mask:0xc
    v_add_f32_dpp v21, v17, v17 row_ror:8 row_mask:0xf bank_mask:0x3
    v_add_f32_dpp v21, v19, v19 row_ror:8 row_mask:0xf bank_mask:0xc
    v_add_f32_dpp v22, v20, v20 row_half_mirror row_mask:0xf bank_mask:0x5
    s_nop 0
    v_add_f32_dpp v22, v21, v21 row_half_mirror row_mask:0xf bank_mask:0xa
    s_nop 1
    v_add_f32_dpp v23, v22, v22 quad_perm:[1,0,3,2] row_mask:0xf bank_mask:0xf
    s_nop 1
    v_add_f32_dpp v22, v23, v23 quad_perm:[2,3,0,1] row_mask:0xf bank_mask:0xf
    v_cvt_pk_bf16_f32 v22, v22, v22
    v_and_b32 v22, 0xffff0000, v22
    v_mul_f32 v22, 0x3db504f3, v22
    v_cvt_pk_bf16_f32 v22, v22, v22
    v_and_b32 v22, 0xffff0000, v22
    v_mul_f32 v24, 0x3fb8aa3b, v22
    s_nop 1
    v_max_f32_dpp v25, v24, v24 row_ror:4 row_mask:0xf bank_mask:0xf
    s_nop 1
    v_max_f32_dpp v26, v25, v25 row_ror:8 row_mask:0xf bank_mask:0xf
    v_max_f32 v26, v26, v14
    v_sub_f32 v27, v24, v26
    v_sub_f32 v28, v14, v26
    v_exp_f32 v27, v27
    v_exp_f32 v28, v28
    v_mov_b32 v14, v26
    v_cvt_pk_bf16_f32 v29, v27, 0
    v_lshlrev_b32 v30, 16, v29
    v_fma_f32 v15, v15, v28, v30
    v_mul_f32 v6, v6, v28
    v_mul_f32 v7, v7, v28
    v_mul_f32 v8, v8, v28
    v_mul_f32 v9, v9, v28
    v_mul_f32 v10, v10, v28
    v_mul_f32 v11, v11, v28
    v_mul_f32 v12, v12, v28
    v_mul_f32 v13, v13, v28
    s_waitcnt vmcnt(15)
    v_dot2c_f32_bf16_dpp v6, v29, v52 row_newbcast:0 row_mask:0xf bank_mask:0xf
    v_dot2c_f32_bf16_dpp v7, v30, v52 row_newbcast:0 row_mask:0xf bank_mask:0xf
    v_dot2c_f32_bf16_dpp v8, v29, v53 row_newbcast:0 row_mask:0xf bank_mask:0xf
    v_dot2c_f32_bf16_dpp v9, v30, v53 row_newbcast:0 row_mask:0xf bank_mask:0xf
    v_dot2c_f32_bf16_dpp v10, v29, v54 row_newbcast:0 row_mask:0xf bank_mask:0xf
    v_dot2c_f32_bf16_dpp v11, v30, v54 row_newbcast:0 row_mask:0xf bank_mask:0xf
    v_dot2c_f32_bf16_dpp v12, v29, v55 row_newbcast:0 row_mask:0xf bank_mask:0xf
    v_dot2c_f32_bf16_dpp v13, v30, v55 row_newbcast:0 row_mask:0xf bank_mask:0xf
    buffer_load_dwordx4 v[52:55], v1, s[44:47], s52 offen offset:0 nt
    s_waitcnt vmcnt(15)
    v_dot2c_f32_bf16_dpp v6, v29, v56 row_newbcast:4 row_mask:0xf bank_mask:0xf
    v_dot2c_f32_bf16_dpp v7, v30, v56 row_newbcast:4 row_mask:0xf bank_mask:0xf
    v_dot2c_f32_bf16_dpp v8, v29, v57 row_newbcast:4 row_mask:0xf bank_mask:0xf
    v_dot2c_f32_bf16_dpp v9, v30, v57 row_newbcast:4 row_mask:0xf bank_mask:0xf
    v_dot2c_f32_bf16_dpp v10, v29, v58 row_newbcast:4 row_mask:0xf bank_mask:0xf
    v_dot2c_f32_bf16_dpp v11, v30, v58 row_newbcast:4 row_mask:0xf bank_mask:0xf
    v_dot2c_f32_bf16_dpp v12, v29, v59 row_newbcast:4 row_mask:0xf bank_mask:0xf
    v_dot2c_f32_bf16_dpp v13, v30, v59 row_newbcast:4 row_mask:0xf bank_mask:0xf
    buffer_load_dwordx4 v[56:59], v1, s[44:47], s52 offen offset:1024 nt
    s_waitcnt vmcnt(15)
    v_dot2c_f32_bf16_dpp v6, v29, v60 row_newbcast:8 row_mask:0xf bank_mask:0xf
    v_dot2c_f32_bf16_dpp v7, v30, v60 row_newbcast:8 row_mask:0xf bank_mask:0xf
    v_dot2c_f32_bf16_dpp v8, v29, v61 row_newbcast:8 row_mask:0xf bank_mask:0xf
    v_dot2c_f32_bf16_dpp v9, v30, v61 row_newbcast:8 row_mask:0xf bank_mask:0xf
    v_dot2c_f32_bf16_dpp v10, v29, v62 row_newbcast:8 row_mask:0xf bank_mask:0xf
    v_dot2c_f32_bf16_dpp v11, v30, v62 row_newbcast:8 row_mask:0xf bank_mask:0xf
    v_dot2c_f32_bf16_dpp v12, v29, v63 row_newbcast:8 row_mask:0xf bank_mask:0xf
    v_dot2c_f32_bf16_dpp v13, v30, v63 row_newbcast:8 row_mask:0xf bank_mask:0xf
    buffer_load_dwordx4 v[60:63], v1, s[44:47], s52 offen offset:2048 nt
    s_waitcnt vmcnt(15)
    v_dot2c_f32_bf16_dpp v6, v29, v64 row_newbcast:12 row_mask:0xf bank_mask:0xf
    v_dot2c_f32_bf16_dpp v7, v30, v64 row_newbcast:12 row_mask:0xf bank_mask:0xf
    v_dot2c_f32_bf16_dpp v8, v29, v65 row_newbcast:12 row_mask:0xf bank_mask:0xf
    v_dot2c_f32_bf16_dpp v9, v30, v65 row_newbcast:12 row_mask:0xf bank_mask:0xf
    v_dot2c_f32_bf16_dpp v10, v29, v66 row_newbcast:12 row_mask:0xf bank_mask:0xf
    v_dot2c_f32_bf16_dpp v11, v30, v66 row_newbcast:12 row_mask:0xf bank_mask:0xf
    v_dot2c_f32_bf16_dpp v12, v29, v67 row_newbcast:12 row_mask:0xf bank_mask:0xf
    v_dot2c_f32_bf16_dpp v13, v30, v67 row_newbcast:12 row_mask:0xf bank_mask:0xf
    buffer_load_dwordx4 v[64:67], v1, s[44:47], s52 offen offset:3072 nt
    s_add_u32 s57, s57, 1
    s_cmp_eq_u32 s56, 0
    s_cbranch_scc1 L_fin
    s_mov_b32 s52, s71
    s_add_u32 s53, s53, 1
    s_cmp_lt_u32 s52, 512
    s_cselect_b32 s42, 0x200000, 0
    s_cselect_b32 s46, 0x200000, 0
    s_cselect_b32 s56, 1, 0
    s_add_u32 s52, s52, s58
    s_and_b32 s52, s52, 511
    s_lshl_b32 s52, s52, 12
    s_waitcnt vmcnt(15)
    v_dot2_f32_bf16 v16, v68, v2, 0
    v_dot2_f32_bf16 v16, v69, v3, v16
    v_dot2_f32_bf16 v16, v70, v4, v16
    v_dot2_f32_bf16 v16, v71, v5, v16
    buffer_load_dwordx4 v[68:71], v1, s[40:43], s52 offen offset:0 nt
    s_waitcnt vmcnt(15)
    v_dot2_f32_bf16 v17, v72, v2, 0
    v_dot2_f32_bf16 v17, v73, v3, v17
    v_dot2_f32_bf16 v17, v74, v4, v17
    v_dot2_f32_bf16 v17, v75, v5, v17
    buffer_load_dwordx4 v[72:75], v1, s[40:43], s52 offen offset:1024 nt
    s_waitcnt vmcnt(15)
    v_dot2_f32_bf16 v18, v76, v2, 0
    v_dot2_f32_bf16 v18, v77, v3, v18
    v_dot2_f32_bf16 v18, v78, v4, v18
    v_dot2_f32_bf16 v18, v79, v5, v18
    buffer_load_dwordx4 v[76:79], v1, s[40:43], s52 offen offset:2048 nt
    s_waitcnt vmcnt(15)
    v_dot2_f32_bf16 v19, v80, v2, 0
    v_dot2_f32_bf16 v19, v81, v3, v19
    v_dot2_f32_bf16 v19, v82, v4, v19
    v_dot2_f32_bf16 v19, v83, v5, v19
    buffer_load_dwordx4 v[80:83], v1, s[40:43], s52 offen offset:3072 nt
    v_add_f32_dpp v20, v16, v16 row_ror:8 row_mask:0xf bank_mask:0x3
    v_add_f32_dpp v20, v18, v18 row_ror:8 row_mask:0xf bank_mask:0xc
    v_add_f32_dpp v21, v17, v17 row_ror:8 row_mask:0xf bank_mask:0x3
    v_add_f32_dpp v21, v19, v19 row_ror:8 row_mask:0xf bank_mask:0xc
    v_add_f32_dpp v22, v20, v20 row_half_mirror row_mask:0xf bank_mask:0x5
    s_nop 0
    v_add_f32_dpp v22, v21, v21 row_half_mirror row_mask:0xf bank_mask:0xa
    s_nop 1
    v_add_f32_dpp v23, v22, v22 quad_perm:[1,0,3,2] row_mask:0xf bank_mask:0xf
    s_nop 1
    v_add_f32_dpp v22, v23, v23 quad_perm:[2,3,0,1] row_mask:0xf bank_mask:0xf
    v_cvt_pk_bf16_f32 v22, v22, v22
    v_and_b32 v22, 0xffff0000, v22
    v_mul_f32 v22, 0x3db504f3, v22
    v_cvt_pk_bf16_f32 v22, v22, v22
    v_and_b32 v22, 0xffff0000, v22
    v_mul_f32 v24, 0x3fb8aa3b, v22
    s_nop 1
    v_max_f32_dpp v25, v24, v24 row_ror:4 row_mask:0xf bank_mask:0xf
    s_nop 1
    v_max_f32_dpp v26, v25, v25 row_ror:8 row_mask:0xf bank_mask:0xf
    v_max_f32 v26, v26, v14
    v_sub_f32 v27, v24, v26
    v_sub_f32 v28, v14, v26
    v_exp_f32 v27, v27
    v_exp_f32 v28, v28
    v_mov_b32 v14, v26
    v_cvt_pk_bf16_f32 v29, v27, 0
    v_lshlrev_b32 v30, 16, v29
    v_fma_f32 v15, v15, v28, v30
    v_mul_f32 v6, v6, v28
    v_mul_f32 v7, v7, v28
    v_mul_f32 v8, v8, v28
    v_mul_f32 v9, v9, v28
    v_mul_f32 v10, v10, v28
    v_mul_f32 v11, v11, v28
    v_mul_f32 v12, v12, v28
    v_mul_f32 v13, v13, v28
    s_waitcnt vmcnt(15)
    v_dot2c_f32_bf16_dpp v6, v29, v84 row_newbcast:0 row_mask:0xf bank_mask:0xf
    v_dot2c_f32_bf16_dpp v7, v30, v84 row_newbcast:0 row_mask:0xf bank_mask:0xf
    v_dot2c_f32_bf16_dpp v8, v29, v85 row_newbcast:0 row_mask:0xf bank_mask:0xf
    v_dot2c_f32_bf16_dpp v9, v30, v85 row_newbcast:0 row_mask:0xf bank_mask:0xf
    v_dot2c_f32_bf16_dpp v10, v29, v86 row_newbcast:0 row_mask:0xf bank_mask:0xf
    v_dot2c_f32_bf16_dpp v11, v30, v86 row_newbcast:0 row_mask:0xf bank_mask:0xf
    v_dot2c_f32_bf16_dpp v12, v29, v87 row_newbcast:0 row_mask:0xf bank_mask:0xf
    v_dot2c_f32_bf16_dpp v13, v30, v87 row_newbcast:0 row_mask:0xf bank_mask:0xf
    buffer_load_dwordx4 v[84:87], v1, s[44:47], s52 offen offset:0 nt
    s_waitcnt vmcnt(15)
    v_dot2c_f32_bf16_dpp v6, v29, v88 row_newbcast:4 row_mask:0xf bank_mask:0xf
    v_dot2c_f32_bf16_dpp v7, v30, v88 row_newbcast:4 row_mask:0xf bank_mask:0xf
    v_dot2c_f32_bf16_dpp v8, v29, v89 row_newbcast:4 row_mask:0xf bank_mask:0xf
    v_dot2c_f32_bf16_dpp v9, v30, v89 row_newbcast:4 row_mask:0xf bank_mask:0xf
    v_dot2c_f32_bf16_dpp v10, v29, v90 row_newbcast:4 row_mask:0xf bank_mask:0xf
    v_dot2c_f32_bf16_dpp v11, v30, v90 row_newbcast:4 row_mask:0xf bank_mask:0xf
    v_dot2c_f32_bf16_dpp v12, v29, v91 row_newbcast:4 row_mask:0xf bank_mask:0xf
    v_dot2c_f32_bf16_dpp v13, v30, v91 row_newbcast:4 row_mask:0xf bank_mask:0xf
    buffer_load_dwordx4 v[88:91], v1, s[44:47], s52 offen offset:1024 nt
    s_waitcnt vmcnt(15)
    v_dot2c_f32_bf16_dpp v6, v29, v92 row_newbcast:8 row_mask:0xf bank_mask:0xf
    v_dot2c_f32_bf16_dpp v7, v30, v92 row_newbcast:8 row_mask:0xf bank_mask:0xf
    v_dot2c_f32_bf16_dpp v8, v29, v93 row_newbcast:8 row_mask:0xf bank_mask:0xf
    v_dot2c_f32_bf16_dpp v9, v30, v93 row_newbcast:8 row_mask:0xf bank_mask:0xf
    v_dot2c_f32_bf16_dpp v10, v29, v94 row_newbcast:8 row_mask:0xf bank_mask:0xf
    v_dot2c_f32_bf16_dpp v11, v30, v94 row_newbcast:8 row_mask:0xf bank_mask:0xf
    v_dot2c_f32_bf16_dpp v12, v29, v95 row_newbcast:8 row_mask:0xf bank_mask:0xf
    v_dot2c_f32_bf16_dpp v13, v30, v95 row_newbcast:8 row_mask:0xf bank_mask:0xf
    buffer_load_dwordx4 v[92:95], v1, s[44:47], s52 offen offset:2048 nt
    s_waitcnt vmcnt(15)
    v_dot2c_f32_bf16_dpp v6, v29, v96 row_newbcast:12 row_mask:0xf bank_mask:0xf
    v_dot2c_f32_bf16_dpp v7, v30, v96 row_newbcast:12 row_mask:0xf bank_mask:0xf
    v_dot2c_f32_bf16_dpp v8, v29, v97 row_newbcast:12 row_mask:0xf bank_mask:0xf
    v_dot2c_f32_bf16_dpp v9, v30, v97 row_newbcast:12 row_mask:0xf bank_mask:0xf
    v_dot2c_f32_bf16_dpp v10, v29, v98 row_newbcast:12 row_mask:0xf bank_mask:0xf
    v_dot2c_f32_bf16_dpp v11, v30, v98 row_newbcast:12 row_mask:0xf bank_mask:0xf
    v_dot2c_f32_bf16_dpp v12, v29, v99 row_newbcast:12 row_mask:0xf bank_mask:0xf
    v_dot2c_f32_bf16_dpp v13, v30, v99 row_newbcast:12 row_mask:0xf bank_mask:0xf
    buffer_load_dwordx4 v[96:99], v1, s[44:47], s52 offen offset:3072 nt
    s_add_u32 s57, s57, 1
    s_branch L_loop
L_park0:
    v_dot2_f32_bf16 v16, v100, v2, 0
    v_dot2_f32_bf16 v16, v101, v3, v16
    v_dot2_f32_bf16 v16, v102, v4, v16
    v_dot2_f32_bf16 v16, v103, v5, v16
    v_dot2_f32_bf16 v17, v104, v2, 0
    v_dot2_f32_bf16 v17, v105, v3, v17
    v_dot2_f32_bf16 v17, v106, v4, v17
    v_dot2_f32_bf16 v17, v107, v5, v17
    v_dot2_f32_bf16 v18, v108, v2, 0
    v_dot2_f32_bf16 v18, v109, v3, v18
    v_dot2_f32_bf16 v18, v110, v4, v18
    v_dot2_f32_bf16 v18, v111, v5, v18
    v_dot2_f32_bf16 v19, v112, v2, 0
    v_dot2_f32_bf16 v19, v113, v3, v19
    v_dot2_f32_bf16 v19, v114, v4, v19
    v_dot2_f32_bf16 v19, v115, v5, v19
    v_add_f32_dpp v20, v16, v16 row_ror:8 row_mask:0xf bank_mask:0x3
    v_add_f32_dpp v20, v18, v18 row_ror:8 row_mask:0xf bank_mask:0xc
    v_add_f32_dpp v21, v17, v17 row_ror:8 row_mask:0xf bank_mask:0x3
    v_add_f32_dpp v21, v19, v19 row_ror:8 row_mask:0xf bank_mask:0xc
    v_add_f32_dpp v22, v20, v20 row_half_mirror row_mask:0xf bank_mask:0x5
    s_nop 0
    v_add_f32_dpp v22, v21, v21 row_half_mirror row_mask:0xf bank_mask:0xa
    s_nop 1
    v_add_f32_dpp v23, v22, v22 quad_perm:[1,0,3,2] row_mask:0xf bank_mask:0xf
    s_nop 1
    v_add_f32_dpp v22, v23, v23 quad_perm:[2,3,0,1] row_mask:0xf bank_mask:0xf
    v_cvt_pk_bf16_f32 v22, v22, v22
    v_and_b32 v22, 0xffff0000, v22
    v_mul_f32 v22, 0x3db504f3, v22
    v_cvt_pk_bf16_f32 v22, v22, v22
    v_and_b32 v22, 0xffff0000, v22
    v_mul_f32 v24, 0x3fb8aa3b, v22
    s_nop 1
    v_max_f32_dpp v25, v24, v24 row_ror:4 row_mask:0xf bank_mask:0xf
    s_nop 1
    v_max_f32_dpp v26, v25, v25 row_ror:8 row_mask:0xf bank_mask:0xf
    v_max_f32 v26, v26, v14
    v_sub_f32 v27, v24, v26
    v_sub_f32 v28, v14, v26
    v_exp_f32 v27, v27
    v_exp_f32 v28, v28
    v_mov_b32 v14, v26
    v_cvt_pk_bf16_f32 v29, v27, 0
    v_lshlrev_b32 v30, 16, v29
    v_fma_f32 v15, v15, v28, v30
    v_mul_f32 v6, v6, v28
    v_mul_f32 v7, v7, v28
    v_mul_f32 v8, v8, v28
    v_mul_f32 v9, v9, v28
    v_mul_f32 v10, v10, v28
    v_mul_f32 v11, v11, v28
    v_mul_f32 v12, v12, v28
    v_mul_f32 v13, v13, v28
    v_dot2c_f32_bf16_dpp v6, v29, v116 row_newbcast:0 row_mask:0xf bank_mask:0xf
    v_dot2c_f32_bf16_dpp v7, v30, v116 row_newbcast:0 row_mask:0xf bank_mask:0xf
    v_dot2c_f32_bf16_dpp v8, v29, v117 row_newbcast:0 row_mask:0xf bank_mask:0xf
    v_dot2c_f32_bf16_dpp v9, v30, v117 row_newbcast:0 row_mask:0xf bank_mask:0xf
    v_dot2c_f32_bf16_dpp v10, v29, v118 row_newbcast:0 row_mask:0xf bank_mask:0xf
    v_dot2c_f32_bf16_dpp v11, v30, v118 row_newbcast:0 row_mask:0xf bank_mask:0xf
    v_dot2c_f32_bf16_dpp v12, v29, v119 row_newbcast:0 row_mask:0xf bank_mask:0xf
    v_dot2c_f32_bf16_dpp v13, v30, v119 row_newbcast:0 row_mask:0xf bank_mask:0xf
    v_dot2c_f32_bf16_dpp v6, v29, v120 row_newbcast:4 row_mask:0xf bank_mask:0xf
    v_dot2c_f32_bf16_dpp v7, v30, v120 row_newbcast:4 row_mask:0xf bank_mask:0xf
    v_dot2c_f32_bf16_dpp v8, v29, v121 row_newbcast:4 row_mask:0xf bank_mask:0xf
    v_dot2c_f32_bf16_dpp v9, v30, v121 row_newbcast:4 row_mask:0xf bank_mask:0xf
    v_dot2c_f32_bf16_dpp v10, v29, v122 row_newbcast:4 row_mask:0xf bank_mask:0xf
    v_dot2c_f32_bf16_dpp v11, v30, v122 row_newbcast:4 row_mask:0xf bank_mask:0xf
    v_dot2c_f32_bf16_dpp v12, v29, v123 row_newbcast:4 row_mask:0xf bank_mask:0xf
    v_dot2c_f32_bf16_dpp v13, v30, v123 row_newbcast:4 row_mask:0xf bank_mask:0xf
    v_dot2c_f32_bf16_dpp v6, v29, v124 row_newbcast:8 row_mask:0xf bank_mask:0xf
    v_dot2c_f32_bf16_dpp v7, v30, v124 row_newbcast:8 row_mask:0xf bank_mask:0xf
    v_dot2c_f32_bf16_dpp v8, v29, v125 row_newbcast:8 row_mask:0xf bank_mask:0xf
    v_dot2c_f32_bf16_dpp v9, v30, v125 row_newbcast:8 row_mask:0xf bank_mask:0xf
    v_dot2c_f32_bf16_dpp v10, v29, v126 row_newbcast:8 row_mask:0xf bank_mask:0xf
    v_dot2c_f32_bf16_dpp v11, v30, v126 row_newbcast:8 row_mask:0xf bank_mask:0xf
    v_dot2c_f32_bf16_dpp v12, v29, v127 row_newbcast:8 row_mask:0xf bank_mask:0xf
    v_dot2c_f32_bf16_dpp v13, v30, v127 row_newbcast:8 row_mask:0xf bank_mask:0xf
    v_dot2c_f32_bf16_dpp v6, v29, v128 row_newbcast:12 row_mask:0xf bank_mask:0xf
    v_dot2c_f32_bf16_dpp v7, v30, v128 row_newbcast:12 row_mask:0xf bank_mask:0xf
    v_dot2c_f32_bf16_dpp v8, v29, v129 row_newbcast:12 row_mask:0xf bank_mask:0xf
    v_dot2c_f32_bf16_dpp v9, v30, v129 row_newbcast:12 row_mask:0xf bank_mask:0xf
    v_dot2c_f32_bf16_dpp v10, v29, v130 row_newbcast:12 row_mask:0xf bank_mask:0xf
    v_dot2c_f32_bf16_dpp v11, v30, v130 row_newbcast:12 row_mask:0xf bank_mask:0xf
    v_dot2c_f32_bf16_dpp v12, v29, v131 row_newbcast:12 row_mask:0xf bank_mask:0xf
    v_dot2c_f32_bf16_dpp v13, v30, v131 row_newbcast:12 row_mask:0xf bank_mask:0xf
    s_branch L_park0_ret
L_park1:
    v_dot2_f32_bf16 v16, v132, v2, 0
    v_dot2_f32_bf16 v16, v133, v3, v16
    v_dot2_f32_bf16 v16, v134, v4, v16
    v_dot2_f32_bf16 v16, v135, v5, v16
    v_dot2_f32_bf16 v17, v136, v2, 0
    v_dot2_f32_bf16 v17, v137, v3, v17
    v_dot2_f32_bf16 v17, v138, v4, v17
    v_dot2_f32_bf16 v17, v139, v5, v17
    v_dot2_f32_bf16 v18, v140, v2, 0
    v_dot2_f32_bf16 v18, v141, v3, v18
    v_dot2_f32_bf16 v18, v142, v4, v18
    v_dot2_f32_bf16 v18, v143, v5, v18
    v_dot2_f32_bf16 v19, v144, v2, 0
    v_dot2_f32_bf16 v19, v145, v3, v19
    v_dot2_f32_bf16 v19, v146, v4, v19
    v_dot2_f32_bf16 v19, v147, v5, v19
    v_add_f32_dpp v20, v16, v16 row_ror:8 row_mask:0xf bank_mask:0x3
    v_add_f32_dpp v20, v18, v18 row_ror:8 row_mask:0xf bank_mask:0xc
    v_add_f32_dpp v21, v17, v17 row_ror:8 row_mask:0xf bank_mask:0x3
    v_add_f32_dpp v21, v19, v19 row_ror:8 row_mask:0xf bank_mask:0xc
    v_add_f32_dpp v22, v20, v20 row_half_mirror row_mask:0xf bank_mask:0x5
    s_nop 0
    v_add_f32_dpp v22, v21, v21 row_half_mirror row_mask:0xf bank_mask:0xa
    s_nop 1
    v_add_f32_dpp v23, v22, v22 quad_perm:[1,0,3,2] row_mask:0xf bank_mask:0xf
    s_nop 1
    v_add_f32_dpp v22, v23, v23 quad_perm:[2,3,0,1] row_mask:0xf bank_mask:0xf
    v_cvt_pk_bf16_f32 v22, v22, v22
    v_and_b32 v22, 0xffff0000, v22
    v_mul_f32 v22, 0x3db504f3, v22
    v_cvt_pk_bf16_f32 v22, v22, v22
    v_and_b32 v22, 0xffff0000, v22
    v_mul_f32 v24, 0x3fb8aa3b, v22
    s_nop 1
    v_max_f32_dpp v25, v24, v24 row_ror:4 row_mask:0xf bank_mask:0xf
    s_nop 1
    v_max_f32_dpp v26, v25, v25 row_ror:8 row_mask:0xf bank_mask:0xf
    v_max_f32 v26, v26, v14
    v_sub_f32 v27, v24, v26
    v_sub_f32 v28, v14, v26
    v_exp_f32 v27, v27
    v_exp_f32 v28, v28
    v_mov_b32 v14, v26
    v_cvt_pk_bf16_f32 v29, v27, 0
    v_lshlrev_b32 v30, 16, v29
    v_fma_f32 v15, v15, v28, v30
    v_mul_f32 v6, v6, v28
    v_mul_f32 v7, v7, v28
    v_mul_f32 v8, v8, v28
    v_mul_f32 v9, v9, v28
    v_mul_f32 v10, v10, v28
    v_mul_f32 v11, v11, v28
    v_mul_f32 v12, v12, v28
    v_mul_f32 v13, v13, v28
    v_dot2c_f32_bf16_dpp v6, v29, v148 row_newbcast:0 row_mask:0xf bank_mask:0xf
    v_dot2c_f32_bf16_dpp v7, v30, v148 row_newbcast:0 row_mask:0xf bank_mask:0xf
    v_dot2c_f32_bf16_dpp v8, v29, v149 row_newbcast:0 row_mask:0xf bank_mask:0xf
    v_dot2c_f32_bf16_dpp v9, v30, v149 row_newbcast:0 row_mask:0xf bank_mask:0xf
    v_dot2c_f32_bf16_dpp v10, v29, v150 row_newbcast:0 row_mask:0xf bank_mask:0xf
    v_dot2c_f32_bf16_dpp v11, v30, v150 row_newbcast:0 row_mask:0xf bank_mask:0xf
    v_dot2c_f32_bf16_dpp v12, v29, v151 row_newbcast:0 row_mask:0xf bank_mask:0xf
    v_dot2c_f32_bf16_dpp v13, v30, v151 row_newbcast:0 row_mask:0xf bank_mask:0xf
    v_dot2c_f32_bf16_dpp v6, v29, v152 row_newbcast:4 row_mask:0xf bank_mask:0xf
    v_dot2c_f32_bf16_dpp v7, v30, v152 row_newbcast:4 row_mask:0xf bank_mask:0xf
    v_dot2c_f32_bf16_dpp v8, v29, v153 row_newbcast:4 row_mask:0xf bank_mask:0xf
    v_dot2c_f32_bf16_dpp v9, v30, v153 row_newbcast:4 row_mask:0xf bank_mask:0xf
    v_dot2c_f32_bf16_dpp v10, v29, v154 row_newbcast:4 row_mask:0xf bank_mask:0xf
    v_dot2c_f32_bf16_dpp v11, v30, v154 row_newbcast:4 row_mask:0xf bank_mask:0xf
    v_dot2c_f32_bf16_dpp v12, v29, v155 row_newbcast:4 row_mask:0xf bank_mask:0xf
    v_dot2c_f32_bf16_dpp v13, v30, v155 row_newbcast:4 row_mask:0xf bank_mask:0xf
    v_dot2c_f32_bf16_dpp v6, v29, v156 row_newbcast:8 row_mask:0xf bank_mask:0xf
    v_dot2c_f32_bf16_dpp v7, v30, v156 row_newbcast:8 row_mask:0xf bank_mask:0xf
    v_dot2c_f32_bf16_dpp v8, v29, v157 row_newbcast:8 row_mask:0xf bank_mask:0xf
    v_dot2c_f32_bf16_dpp v9, v30, v157 row_newbcast:8 row_mask:0xf bank_mask:0xf
    v_dot2c_f32_bf16_dpp v10, v29, v158 row_newbcast:8 row_mask:0xf bank_mask:0xf
    v_dot2c_f32_bf16_dpp v11, v30, v158 row_newbcast:8 row_mask:0xf bank_mask:0xf
    v_dot2c_f32_bf16_dpp v12, v29, v159 row_newbcast:8 row_mask:0xf bank_mask:0xf
    v_dot2c_f32_bf16_dpp v13, v30, v159 row_newbcast:8 row_mask:0xf bank_mask:0xf
    v_dot2c_f32_bf16_dpp v6, v29, v160 row_newbcast:12 row_mask:0xf bank_mask:0xf
    v_dot2c_f32_bf16_dpp v7, v30, v160 row_newbcast:12 row_mask:0xf bank_mask:0xf
    v_dot2c_f32_bf16_dpp v8, v29, v161 row_newbcast:12 row_mask:0xf bank_mask:0xf
    v_dot2c_f32_bf16_dpp v9, v30, v161 row_newbcast:12 row_mask:0xf bank_mask:0xf
    v_dot2c_f32_bf16_dpp v10, v29, v162 row_newbcast:12 row_mask:0xf bank_mask:0xf
    v_dot2c_f32_bf16_dpp v11, v30, v162 row_newbcast:12 row_mask:0xf bank_mask:0xf
    v_dot2c_f32_bf16_dpp v12, v29, v163 row_newbcast:12 row_mask:0xf bank_mask:0xf
    v_dot2c_f32_bf16_dpp v13, v30, v163 row_newbcast:12 row_mask:0xf bank_mask:0xf
    s_branch L_park1_ret
L_park2:
    v_dot2_f32_bf16 v16, v164, v2, 0
    v_dot2_f32_bf16 v16, v165, v3, v16
    v_dot2_f32_bf16 v16, v166, v4, v16
    v_dot2_f32_bf16 v16, v167, v5, v16
    v_dot2_f32_bf16 v17, v168, v2, 0
    v_dot2_f32_bf16 v17, v169, v3, v17
    v_dot2_f32_bf16 v17, v170, v4, v17
    v_dot2_f32_bf16 v17, v171, v5, v17
    v_dot2_f32_bf16 v18, v172, v2, 0
    v_dot2_f32_bf16 v18, v173, v3, v18
    v_dot2_f32_bf16 v18, v174, v4, v18
    v_dot2_f32_bf16 v18, v175, v5, v18
    v_dot2_f32_bf16 v19, v176, v2, 0
    v_dot2_f32_bf16 v19, v177, v3, v19
    v_dot2_f32_bf16 v19, v178, v4, v19
    v_dot2_f32_bf16 v19, v179, v5, v19
    v_add_f32_dpp v20, v16, v16 row_ror:8 row_mask:0xf bank_mask:0x3
    v_add_f32_dpp v20, v18, v18 row_ror:8 row_mask:0xf bank_mask:0xc
    v_add_f32_dpp v21, v17, v17 row_ror:8 row_mask:0xf bank_mask:0x3
    v_add_f32_dpp v21, v19, v19 row_ror:8 row_mask:0xf bank_mask:0xc
    v_add_f32_dpp v22, v20, v20 row_half_mirror row_mask:0xf bank_mask:0x5
    s_nop 0
    v_add_f32_dpp v22, v21, v21 row_half_mirror row_mask:0xf bank_mask:0xa
    s_nop 1
    v_add_f32_dpp v23, v22, v22 quad_perm:[1,0,3,2] row_mask:0xf bank_mask:0xf
    s_nop 1
    v_add_f32_dpp v22, v23, v23 quad_perm:[2,3,0,1] row_mask:0xf bank_mask:0xf
    v_cvt_pk_bf16_f32 v22, v22, v22
    v_and_b32 v22, 0xffff0000, v22
    v_mul_f32 v22, 0x3db504f3, v22
    v_cvt_pk_bf16_f32 v22, v22, v22
    v_and_b32 v22, 0xffff0000, v22
    v_mul_f32 v24, 0x3fb8aa3b, v22
    s_nop 1
    v_max_f32_dpp v25, v24, v24 row_ror:4 row_mask:0xf bank_mask:0xf
    s_nop 1
    v_max_f32_dpp v26, v25, v25 row_ror:8 row_mask:0xf bank_mask:0xf
    v_max_f32 v26, v26, v14
    v_sub_f32 v27, v24, v26
    v_sub_f32 v28, v14, v26
    v_exp_f32 v27, v27
    v_exp_f32 v28, v28
    v_mov_b32 v14, v26
    v_cvt_pk_bf16_f32 v29, v27, 0
    v_lshlrev_b32 v30, 16, v29
    v_fma_f32 v15, v15, v28, v30
    v_mul_f32 v6, v6, v28
    v_mul_f32 v7, v7, v28
    v_mul_f32 v8, v8, v28
    v_mul_f32 v9, v9, v28
    v_mul_f32 v10, v10, v28
    v_mul_f32 v11, v11, v28
    v_mul_f32 v12, v12, v28
    v_mul_f32 v13, v13, v28
    v_dot2c_f32_bf16_dpp v6, v29, v180 row_newbcast:0 row_mask:0xf bank_mask:0xf
    v_dot2c_f32_bf16_dpp v7, v30, v180 row_newbcast:0 row_mask:0xf bank_mask:0xf
    v_dot2c_f32_bf16_dpp v8, v29, v181 row_newbcast:0 row_mask:0xf bank_mask:0xf
    v_dot2c_f32_bf16_dpp v9, v30, v181 row_newbcast:0 row_mask:0xf bank_mask:0xf
    v_dot2c_f32_bf16_dpp v10, v29, v182 row_newbcast:0 row_mask:0xf bank_mask:0xf
    v_dot2c_f32_bf16_dpp v11, v30, v182 row_newbcast:0 row_mask:0xf bank_mask:0xf
    v_dot2c_f32_bf16_dpp v12, v29, v183 row_newbcast:0 row_mask:0xf bank_mask:0xf
    v_dot2c_f32_bf16_dpp v13, v30, v183 row_newbcast:0 row_mask:0xf bank_mask:0xf
    v_dot2c_f32_bf16_dpp v6, v29, v184 row_newbcast:4 row_mask:0xf bank_mask:0xf
    v_dot2c_f32_bf16_dpp v7, v30, v184 row_newbcast:4 row_mask:0xf bank_mask:0xf
    v_dot2c_f32_bf16_dpp v8, v29, v185 row_newbcast:4 row_mask:0xf bank_mask:0xf
    v_dot2c_f32_bf16_dpp v9, v30, v185 row_newbcast:4 row_mask:0xf bank_mask:0xf
    v_dot2c_f32_bf16_dpp v10, v29, v186 row_newbcast:4 row_mask:0xf bank_mask:0xf
    v_dot2c_f32_bf16_dpp v11, v30, v186 row_newbcast:4 row_mask:0xf bank_mask:0xf
    v_dot2c_f32_bf16_dpp v12, v29, v187 row_newbcast:4 row_mask:0xf bank_mask:0xf
    v_dot2c_f32_bf16_dpp v13, v30, v187 row_newbcast:4 row_mask:0xf bank_mask:0xf
    v_dot2c_f32_bf16_dpp v6, v29, v188 row_newbcast:8 row_mask:0xf bank_mask:0xf
    v_dot2c_f32_bf16_dpp v7, v30, v188 row_newbcast:8 row_mask:0xf bank_mask:0xf
    v_dot2c_f32_bf16_dpp v8, v29, v189 row_newbcast:8 row_mask:0xf bank_mask:0xf
    v_dot2c_f32_bf16_dpp v9, v30, v189 row_newbcast:8 row_mask:0xf bank_mask:0xf
    v_dot2c_f32_bf16_dpp v10, v29, v190 row_newbcast:8 row_mask:0xf bank_mask:0xf
    v_dot2c_f32_bf16_dpp v11, v30, v190 row_newbcast:8 row_mask:0xf bank_mask:0xf
    v_dot2c_f32_bf16_dpp v12, v29, v191 row_newbcast:8 row_mask:0xf bank_mask:0xf
    v_dot2c_f32_bf16_dpp v13, v30, v191 row_newbcast:8 row_mask:0xf bank_mask:0xf
    v_dot2c_f32_bf16_dpp v6, v29, v192 row_newbcast:12 row_mask:0xf bank_mask:0xf
    v_dot2c_f32_bf16_dpp v7, v30, v192 row_newbcast:12 row_mask:0xf bank_mask:0xf
    v_dot2c_f32_bf16_dpp v8, v29, v193 row_newbcast:12 row_mask:0xf bank_mask:0xf
    v_dot2c_f32_bf16_dpp v9, v30, v193 row_newbcast:12 row_mask:0xf bank_mask:0xf
    v_dot2c_f32_bf16_dpp v10, v29, v194 row_newbcast:12 row_mask:0xf bank_mask:0xf
    v_dot2c_f32_bf16_dpp v11, v30, v194 row_newbcast:12 row_mask:0xf bank_mask:0xf
    v_dot2c_f32_bf16_dpp v12, v29, v195 row_newbcast:12 row_mask:0xf bank_mask:0xf
    v_dot2c_f32_bf16_dpp v13, v30, v195 row_newbcast:12 row_mask:0xf bank_mask:0xf
    s_branch L_park2_ret
L_park3:
    v_dot2_f32_bf16 v16, v196, v2, 0
    v_dot2_f32_bf16 v16, v197, v3, v16
    v_dot2_f32_bf16 v16, v198, v4, v16
    v_dot2_f32_bf16 v16, v199, v5, v16
    v_dot2_f32_bf16 v17, v200, v2, 0
    v_dot2_f32_bf16 v17, v201, v3, v17
    v_dot2_f32_bf16 v17, v202, v4, v17
    v_dot2_f32_bf16 v17, v203, v5, v17
    v_dot2_f32_bf16 v18, v204, v2, 0
    v_dot2_f32_bf16 v18, v205, v3, v18
    v_dot2_f32_bf16 v18, v206, v4, v18
    v_dot2_f32_bf16 v18, v207, v5, v18
    v_dot2_f32_bf16 v19, v208, v2, 0
    v_dot2_f32_bf16 v19, v209, v3, v19
    v_dot2_f32_bf16 v19, v210, v4, v19
    v_dot2_f32_bf16 v19, v211, v5, v19
    v_add_f32_dpp v20, v16, v16 row_ror:8 row_mask:0xf bank_mask:0x3
    v_add_f32_dpp v20, v18, v18 row_ror:8 row_mask:0xf bank_mask:0xc
    v_add_f32_dpp v21, v17, v17 row_ror:8 row_mask:0xf bank_mask:0x3
    v_add_f32_dpp v21, v19, v19 row_ror:8 row_mask:0xf bank_mask:0xc
    v_add_f32_dpp v22, v20, v20 row_half_mirror row_mask:0xf bank_mask:0x5
    s_nop 0
    v_add_f32_dpp v22, v21, v21 row_half_mirror row_mask:0xf bank_mask:0xa
    s_nop 1
    v_add_f32_dpp v23, v22, v22 quad_perm:[1,0,3,2] row_mask:0xf bank_mask:0xf
    s_nop 1
    v_add_f32_dpp v22, v23, v23 quad_perm:[2,3,0,1] row_mask:0xf bank_mask:0xf
    v_cvt_pk_bf16_f32 v22, v22, v22
    v_and_b32 v22, 0xffff0000, v22
    v_mul_f32 v22, 0x3db504f3, v22
    v_cvt_pk_bf16_f32 v22, v22, v22
    v_and_b32 v22, 0xffff0000, v22
    v_mul_f32 v24, 0x3fb8aa3b, v22
    s_nop 1
    v_max_f32_dpp v25, v24, v24 row_ror:4 row_mask:0xf bank_mask:0xf
    s_nop 1
    v_max_f32_dpp v26, v25, v25 row_ror:8 row_mask:0xf bank_mask:0xf
    v_max_f32 v26, v26, v14
    v_sub_f32 v27, v24, v26
    v_sub_f32 v28, v14, v26
    v_exp_f32 v27, v27
    v_exp_f32 v28, v28
    v_mov_b32 v14, v26
    v_cvt_pk_bf16_f32 v29, v27, 0
    v_lshlrev_b32 v30, 16, v29
    v_fma_f32 v15, v15, v28, v30
    v_mul_f32 v6, v6, v28
    v_mul_f32 v7, v7, v28
    v_mul_f32 v8, v8, v28
    v_mul_f32 v9, v9, v28
    v_mul_f32 v10, v10, v28
    v_mul_f32 v11, v11, v28
    v_mul_f32 v12, v12, v28
    v_mul_f32 v13, v13, v28
    v_dot2c_f32_bf16_dpp v6, v29, v212 row_newbcast:0 row_mask:0xf bank_mask:0xf
    v_dot2c_f32_bf16_dpp v7, v30, v212 row_newbcast:0 row_mask:0xf bank_mask:0xf
    v_dot2c_f32_bf16_dpp v8, v29, v213 row_newbcast:0 row_mask:0xf bank_mask:0xf
    v_dot2c_f32_bf16_dpp v9, v30, v213 row_newbcast:0 row_mask:0xf bank_mask:0xf
    v_dot2c_f32_bf16_dpp v10, v29, v214 row_newbcast:0 row_mask:0xf bank_mask:0xf
    v_dot2c_f32_bf16_dpp v11, v30, v214 row_newbcast:0 row_mask:0xf bank_mask:0xf
    v_dot2c_f32_bf16_dpp v12, v29, v215 row_newbcast:0 row_mask:0xf bank_mask:0xf
    v_dot2c_f32_bf16_dpp v13, v30, v215 row_newbcast:0 row_mask:0xf bank_mask:0xf
    v_dot2c_f32_bf16_dpp v6, v29, v216 row_newbcast:4 row_mask:0xf bank_mask:0xf
    v_dot2c_f32_bf16_dpp v7, v30, v216 row_newbcast:4 row_mask:0xf bank_mask:0xf
    v_dot2c_f32_bf16_dpp v8, v29, v217 row_newbcast:4 row_mask:0xf bank_mask:0xf
    v_dot2c_f32_bf16_dpp v9, v30, v217 row_newbcast:4 row_mask:0xf bank_mask:0xf
    v_dot2c_f32_bf16_dpp v10, v29, v218 row_newbcast:4 row_mask:0xf bank_mask:0xf
    v_dot2c_f32_bf16_dpp v11, v30, v218 row_newbcast:4 row_mask:0xf bank_mask:0xf
    v_dot2c_f32_bf16_dpp v12, v29, v219 row_newbcast:4 row_mask:0xf bank_mask:0xf
    v_dot2c_f32_bf16_dpp v13, v30, v219 row_newbcast:4 row_mask:0xf bank_mask:0xf
    v_dot2c_f32_bf16_dpp v6, v29, v220 row_newbcast:8 row_mask:0xf bank_mask:0xf
    v_dot2c_f32_bf16_dpp v7, v30, v220 row_newbcast:8 row_mask:0xf bank_mask:0xf
    v_dot2c_f32_bf16_dpp v8, v29, v221 row_newbcast:8 row_mask:0xf bank_mask:0xf
    v_dot2c_f32_bf16_dpp v9, v30, v221 row_newbcast:8 row_mask:0xf bank_mask:0xf
    v_dot2c_f32_bf16_dpp v10, v29, v222 row_newbcast:8 row_mask:0xf bank_mask:0xf
    v_dot2c_f32_bf16_dpp v11, v30, v222 row_newbcast:8 row_mask:0xf bank_mask:0xf
    v_dot2c_f32_bf16_dpp v12, v29, v223 row_newbcast:8 row_mask:0xf bank_mask:0xf
    v_dot2c_f32_bf16_dpp v13, v30, v223 row_newbcast:8 row_mask:0xf bank_mask:0xf
    v_dot2c_f32_bf16_dpp v6, v29, v224 row_newbcast:12 row_mask:0xf bank_mask:0xf
    v_dot2c_f32_bf16_dpp v7, v30, v224 row_newbcast:12 row_mask:0xf bank_mask:0xf
    v_dot2c_f32_bf16_dpp v8, v29, v225 row_newbcast:12 row_mask:0xf bank_mask:0xf
    v_dot2c_f32_bf16_dpp v9, v30, v225 row_newbcast:12 row_mask:0xf bank_mask:0xf
    v_dot2c_f32_bf16_dpp v10, v29, v226 row_newbcast:12 row_mask:0xf bank_mask:0xf
    v_dot2c_f32_bf16_dpp v11, v30, v226 row_newbcast:12 row_mask:0xf bank_mask:0xf
    v_dot2c_f32_bf16_dpp v12, v29, v227 row_newbcast:12 row_mask:0xf bank_mask:0xf
    v_dot2c_f32_bf16_dpp v13, v30, v227 row_newbcast:12 row_mask:0xf bank_mask:0xf
    s_branch L_park3_ret
L_go:
    v_mov_b32 v23, 260
    v_mov_b32 v22, 1
    ds_write_b32 v23, v22
    s_branch L_go_ret
L_go2:
    v_mov_b32 v23, 268
    v_mov_b32 v22, 1
    ds_write_b32 v23, v22
    s_branch L_go2_ret
L_fin:
    v_add_f32_dpp v23, v15, v15 row_ror:4 row_mask:0xf bank_mask:0xf
    v_mov_b32 v26, v14
    s_nop 0
    v_add_f32_dpp v15, v23, v23 row_ror:8 row_mask:0xf bank_mask:0xf
    v_mov_b32 v23, v26
    s_nop 1
    v_permlane16_swap_b32 v23, v26
    v_max_f32 v26, v26, v23
    v_mov_b32 v23, v26
    s_nop 1
    v_permlane32_swap_b32 v23, v26
    v_max_f32 v26, v26, v23
    v_sub_f32 v28, v14, v26
    v_exp_f32 v28, v28
    s_nop 0
    v_mul_f32 v15, v15, v28
    v_mul_f32 v6, v6, v28
    v_mul_f32 v7, v7, v28
    v_mul_f32 v8, v8, v28
    v_mul_f32 v9, v9, v28
    v_mul_f32 v10, v10, v28
    v_mul_f32 v11, v11, v28
    v_mul_f32 v12, v12, v28
    v_mul_f32 v13, v13, v28
    v_mov_b32 v23, v15
    s_nop 1
    v_permlane16_swap_b32 v23, v15
    v_add_f32 v15, v15, v23
    v_mov_b32 v23, v15
    s_nop 1
    v_permlane32_swap_b32 v23, v15
    v_add_f32 v15, v15, v23
    v_permlane32_swap_b32 v6, v10
    v_permlane32_swap_b32 v7, v11
    v_permlane32_swap_b32 v8, v12
    v_permlane32_swap_b32 v9, v13
    v_add_f32 v6, v6, v10
    v_add_f32 v7, v7, v11
    v_add_f32 v8, v8, v12
    v_add_f32 v9, v9, v13
    s_nop 0
    v_permlane16_swap_b32 v6, v8
    v_permlane16_swap_b32 v7, v9
    v_add_f32 v6, v6, v8
    v_add_f32 v7, v7, v9
    v_and_b32 v23, 15, v0
    v_lshrrev_b32 v22, 4, v0
    v_lshlrev_b32 v23, 5, v23
    v_lshl_add_u32 v23, v22, 3, v23
    s_lshl_b32 s52, s28, 9
    v_add_u32 v23, s52, v23
    ds_write_b64 v23, v[6:7] offset:512
    v_mov_b32 v14, v26
    s_lshl_b32 s52, s28, 3
    v_mov_b32 v23, s52
    s_mov_b64 exec, 1
    ds_write_b64 v23, v[14:15] offset:288
    s_mov_b64 exec, -1
    s_waitcnt lgkmcnt(0)
    s_barrier
    s_cmp_lg_u32 s34, 0
    s_cbranch_scc1 L_sdone
    v_mov_b32 v20, 0
    v_lshlrev_b32 v21, 3, v0
    ds_read_b128 v[100:103], v20 offset:288
    ds_read_b128 v[104:107], v20 offset:304
    ds_read_b64 v[108:109], v21 offset:512
    ds_read_b64 v[110:111], v21 offset:1024
    ds_read_b64 v[112:113], v21 offset:1536
    ds_read_b64 v[114:115], v21 offset:2048
    s_lshl_b32 s52, s2, 10
    s_add_u32 s52, s52, 589824
    s_waitcnt lgkmcnt(4)
    v_max_f32 v116, v100, v102
    v_max3_f32 v116, v116, v104, v106
    v_sub_f32 v100, v100, v116
    v_sub_f32 v102, v102, v116
    v_sub_f32 v104, v104, v116
    v_sub_f32 v106, v106, v116
    v_exp_f32 v100, v100
    v_exp_f32 v102, v102
    v_exp_f32 v104, v104
    v_exp_f32 v106, v106
    v_mul_f32 v117, v100, v101
    v_fmac_f32 v117, v102, v103
    v_fmac_f32 v117, v104, v105
    v_fmac_f32 v117, v106, v107
    s_waitcnt lgkmcnt(0)
    v_mul_f32 v118, v100, v108
    v_mul_f32 v119, v100, v109
    v_fmac_f32 v118, v102, v110
    v_fmac_f32 v119, v102, v111
    v_fmac_f32 v118, v104, v112
    v_fmac_f32 v119, v104, v113
    v_fmac_f32 v118, v106, v114
    v_fmac_f32 v119, v106, v115
    s_mov_b32 s53, 0xfffffffe
    v_min_u32 v116, s53, v116
    v_min_u32 v117, s53, v117
    v_min_u32 v118, s53, v118
    v_min_u32 v119, s53, v119
    buffer_store_dwordx2 v[118:119], v21, s[36:39], s52 offen sc1
    s_mov_b64 exec, 1
    buffer_store_dwordx2 v[116:117], v20, s[36:39], s52 offen offset:512 sc1
    s_mov_b64 exec, -1
L_sdone:
    s_endpgm
L_helper:
    s_setprio 1
    s_and_b32 s68, s29, 1
    s_lshl1_add_u32 s68, s30, s68
    s_lshr_b32 s66, s29, 1
    s_lshl4_add_u32 s69, s66, s68
    s_and_b32 s52, s30, 1
    s_lshl_b32 s52, s52, 1
    s_bfe_u32 s53, s30, 0x10001
    s_or_b32 s52, s52, s53
    s_and_b32 s53, s30, 4
    s_or_b32 s52, s52, s53
    s_mul_i32 s52, s52, 10
    s_add_u32 s53, s52, s29
    s_sub_u32 s53, s53, 22
    s_cmp_lt_u32 s53, 43
    s_cselect_b32 s67, 2, 0
    s_cmp_lt_u32 s29, 22
    s_cselect_b32 s67, 1, s67
    s_cselect_b32 s66, s66, s53
    v_lshrrev_b32 v1, 4, v0
    v_and_b32 v2, 15, v0
    s_mov_b32 s44, s10
    s_mov_b32 s45, s11
    s_mov_b32 s46, 0x400000
    s_mov_b32 s47, 0x20000
    s_mov_b32 s40, s4
    s_mov_b32 s41, s5
    s_mov_b32 s42, 2048
    s_mov_b32 s43, 0x20000
    v_lshrrev_b32 v3, 3, v2
    v_lshlrev_b32 v4, 2, v3
    v_add_u32 v4, v4, v1
    v_lshlrev_b32 v5, 16, v4
    v_and_b32 v6, 7, v2
    v_lshl_add_u32 v5, v6, 3, v5
    s_lshl_b32 s52, s30, 19
    s_lshl_b32 s53, s29, 8
    s_add_u32 s52, s52, s53
    s_lshl_b32 s53, s34, 6
    s_add_u32 s52, s52, s53
    buffer_load_dwordx2 v[16:17], v5, s[44:47], s52 offen nt
    s_add_u32 s52, s52, 8192
    buffer_load_dwordx2 v[18:19], v5, s[44:47], s52 offen nt
    s_add_u32 s52, s52, 8192
    buffer_load_dwordx2 v[20:21], v5, s[44:47], s52 offen nt
    s_add_u32 s52, s52, 8192
    buffer_load_dwordx2 v[22:23], v5, s[44:47], s52 offen nt
    s_add_u32 s52, s52, 8192
    buffer_load_dwordx2 v[24:25], v5, s[44:47], s52 offen nt
    s_add_u32 s52, s52, 8192
    buffer_load_dwordx2 v[26:27], v5, s[44:47], s52 offen nt
    s_add_u32 s52, s52, 8192
    buffer_load_dwordx2 v[28:29], v5, s[44:47], s52 offen nt
    s_add_u32 s52, s52, 8192
    buffer_load_dwordx2 v[30:31], v5, s[44:47], s52 offen nt
    v_and_b32 v7, 1, v0
    v_lshlrev_b32 v7, 10, v7
    v_lshrrev_b32 v8, 1, v0
    v_lshl_add_u32 v8, v8, 5, v7
    buffer_load_dwordx4 v[48:51], v8, s[40:43], 0 offen
    buffer_load_dwordx4 v[52:55], v8, s[40:43], 0 offen offset:16
    v_bfe_u32 v9, v2, 1, 1
    v_lshlrev_b32 v9, 2, v9
    v_add_u32 v9, v9, v1
    v_lshl_add_u32 v9, v9, 4, v7
    s_lshl_b32 s53, s30, 7
    buffer_load_dwordx4 v[56:59], v9, s[40:43], s53 offen
    s_load_dword s35, s[26:27], 0
    v_mov_b32 v14, 0
    v_mov_b32 v15, 0
    v_mov_b32 v12, 256
    ds_write_b64 v12, v[14:15]
    ds_write_b64 v12, v[14:15] offset:8
    v_lshlrev_b32 v12, 2, v0
    s_lshl_b32 s64, s34, 8
    v_add_u32 v12, s64, v12
    v_mov_b32 v14, -1
    ds_write_b32 v12, v14 offset:13312
    s_mov_b32 s64, 0x05040100
    s_mov_b32 s65, 0x07060302
    s_waitcnt vmcnt(1)
    v_lshlrev_b32 v64, 16, v48
    v_and_b32 v65, 0xffff0000, v48
    v_lshlrev_b32 v66, 16, v49
    v_and_b32 v67, 0xffff0000, v49
    v_lshlrev_b32 v68, 16, v50
    v_and_b32 v69, 0xffff0000, v50
    v_lshlrev_b32 v70, 16, v51
    v_and_b32 v71, 0xffff0000, v51
    v_lshlrev_b32 v72, 16, v52
    v_and_b32 v73, 0xffff0000, v52
    v_lshlrev_b32 v74, 16, v53
    v_and_b32 v75, 0xffff0000, v53
    v_lshlrev_b32 v76, 16, v54
    v_and_b32 v77, 0xffff0000, v54
    v_lshlrev_b32 v78, 16, v55
    v_and_b32 v79, 0xffff0000, v55
    v_add_f32 v12, v64, v65
    v_add_f32 v13, v66, v67
    v_add_f32 v12, v12, v68
    v_add_f32 v13, v13, v69
    v_add_f32 v12, v12, v70
    v_add_f32 v13, v13, v71
    v_add_f32 v12, v12, v72
    v_add_f32 v13, v13, v73
    v_add_f32 v12, v12, v74
    v_add_f32 v13, v13, v75
    v_add_f32 v12, v12, v76
    v_add_f32 v13, v13, v77
    v_add_f32 v12, v12, v78
    v_add_f32 v13, v13, v79
    v_add_f32 v12, v12, v13
    s_nop 1
    v_add_f32_dpp v13, v12, v12 row_ror:2 row_mask:0xf bank_mask:0xf
    s_nop 1
    v_add_f32_dpp v12, v13, v13 row_ror:4 row_mask:0xf bank_mask:0xf
    s_nop 1
    v_add_f32_dpp v13, v12, v12 row_ror:8 row_mask:0xf bank_mask:0xf
    v_mov_b32 v12, v13
    v_mov_b32 v13, v12
    s_nop 1
    v_permlane16_swap_b32 v13, v12
    v_add_f32 v12, v12, v13
    v_mov_b32 v13, v12
    s_nop 1
    v_permlane32_swap_b32 v13, v12
    v_add_f32 v12, v12, v13
    v_mul_f32 v12, 0x3b000000, v12
    v_mov_b32 v14, 0
    v_mov_b32 v15, 0
    v_sub_f32 v64, v64, v12
    v_sub_f32 v65, v65, v12
    v_sub_f32 v66, v66, v12
    v_sub_f32 v67, v67, v12
    v_sub_f32 v68, v68, v12
    v_sub_f32 v69, v69, v12
    v_sub_f32 v70, v70, v12
    v_sub_f32 v71, v71, v12
    v_sub_f32 v72, v72, v12
    v_sub_f32 v73, v73, v12
    v_sub_f32 v74, v74, v12
    v_sub_f32 v75, v75, v12
    v_sub_f32 v76, v76, v12
    v_sub_f32 v77, v77, v12
    v_sub_f32 v78, v78, v12
    v_sub_f32 v79, v79, v12
    v_fmac_f32 v14, v64, v64
    v_fmac_f32 v15, v65, v65
    v_fmac_f32 v14, v66, v66
    v_fmac_f32 v15, v67, v67
    v_fmac_f32 v14, v68, v68
    v_fmac_f32 v15, v69, v69
    v_fmac_f32 v14, v70, v70
    v_fmac_f32 v15, v71, v71
    v_fmac_f32 v14, v72, v72
    v_fmac_f32 v15, v73, v73
    v_fmac_f32 v14, v74, v74
    v_fmac_f32 v15, v75, v75
    v_fmac_f32 v14, v76, v76
    v_fmac_f32 v15, v77, v77
    v_fmac_f32 v14, v78, v78
    v_fmac_f32 v15, v79, v79
    v_add_f32 v14, v14, v15
    s_nop 1
    v_add_f32_dpp v13, v14, v14 row_ror:2 row_mask:0xf bank_mask:0xf
    s_nop 1
    v_add_f32_dpp v14, v13, v13 row_ror:4 row_mask:0xf bank_mask:0xf
    s_nop 1
    v_add_f32_dpp v13, v14, v14 row_ror:8 row_mask:0xf bank_mask:0xf
    v_mov_b32 v14, v13
    v_mov_b32 v13, v14
    s_nop 1
    v_permlane16_swap_b32 v13, v14
    v_add_f32 v14, v14, v13
    v_mov_b32 v13, v14
    s_nop 1
    v_permlane32_swap_b32 v13, v14
    v_add_f32 v14, v14, v13
    v_mul_f32 v14, 0x3b000000, v14
    v_cvt_pk_bf16_f32 v14, v14, v14
    v_and_b32 v14, 0xffff0000, v14
    v_add_f32 v14, 0x3727c5ac, v14
    v_cvt_pk_bf16_f32 v14, v14, v14
    v_and_b32 v14, 0xffff0000, v14
    v_sqrt_f32 v14, v14
    s_nop 0
    v_cvt_pk_bf16_f32 v14, v14, v14
    v_and_b32 v14, 0xffff0000, v14
    v_rcp_f32 v14, v14
    v_cvt_pk_bf16_f32 v12, v12, v12
    v_and_b32 v12, 0xffff0000, v12
    s_waitcnt vmcnt(0)
    v_lshlrev_b32 v64, 16, v56
    v_and_b32 v65, 0xffff0000, v56
    v_sub_f32 v64, v64, v12
    v_sub_f32 v65, v65, v12
    v_cvt_pk_bf16_f32 v66, v64, v65
    v_lshlrev_b32 v64, 16, v66
    v_and_b32 v65, 0xffff0000, v66
    v_mul_f32 v64, v64, v14
    v_mul_f32 v65, v65, v14
    v_cvt_pk_bf16_f32 v60, v64, v65
    v_lshlrev_b32 v64, 16, v57
    v_and_b32 v65, 0xffff0000, v57
    v_sub_f32 v64, v64, v12
    v_sub_f32 v65, v65, v12
    v_cvt_pk_bf16_f32 v66, v64, v65
    v_lshlrev_b32 v64, 16, v66
    v_and_b32 v65, 0xffff0000, v66
    v_mul_f32 v64, v64, v14
    v_mul_f32 v65, v65, v14
    v_cvt_pk_bf16_f32 v61, v64, v65
    v_lshlrev_b32 v64, 16, v58
    v_and_b32 v65, 0xffff0000, v58
    v_sub_f32 v64, v64, v12
    v_sub_f32 v65, v65, v12
    v_cvt_pk_bf16_f32 v66, v64, v65
    v_lshlrev_b32 v64, 16, v66
    v_and_b32 v65, 0xffff0000, v66
    v_mul_f32 v64, v64, v14
    v_mul_f32 v65, v65, v14
    v_cvt_pk_bf16_f32 v62, v64, v65
    v_lshlrev_b32 v64, 16, v59
    v_and_b32 v65, 0xffff0000, v59
    v_sub_f32 v64, v64, v12
    v_sub_f32 v65, v65, v12
    v_cvt_pk_bf16_f32 v66, v64, v65
    v_lshlrev_b32 v64, 16, v66
    v_and_b32 v65, 0xffff0000, v66
    v_mul_f32 v64, v64, v14
    v_mul_f32 v65, v65, v14
    v_cvt_pk_bf16_f32 v63, v64, v65
    v_perm_b32 v32, v18, v16, s64
    v_perm_b32 v33, v22, v20, s64
    v_perm_b32 v34, v26, v24, s64
    v_perm_b32 v35, v30, v28, s64
    v_perm_b32 v36, v18, v16, s65
    v_perm_b32 v37, v22, v20, s65
    v_perm_b32 v38, v26, v24, s65
    v_perm_b32 v39, v30, v28, s65
    v_perm_b32 v40, v19, v17, s64
    v_perm_b32 v41, v23, v21, s64
    v_perm_b32 v42, v27, v25, s64
    v_perm_b32 v43, v31, v29, s64
    v_perm_b32 v44, v19, v17, s65
    v_perm_b32 v45, v23, v21, s65
    v_perm_b32 v46, v27, v25, s65
    v_perm_b32 v47, v31, v29, s65
    v_mfma_f32_16x16x32_bf16 v[80:83], v[60:63], v[32:35], 0
    v_mfma_f32_16x16x32_bf16 v[84:87], v[60:63], v[36:39], 0
    v_mfma_f32_16x16x32_bf16 v[88:91], v[60:63], v[40:43], 0
    v_mfma_f32_16x16x32_bf16 v[92:95], v[60:63], v[44:47], 0
    s_waitcnt lgkmcnt(0)
    s_mul_i32 s35, s35, 0x9E3779B1
    s_add_u32 s35, s35, 0x7F4A7C15
    v_mov_b32 v97, s35
    v_mov_b32 v99, s35
    v_mov_b32 v101, s35
    v_mov_b32 v103, s35
    v_add_f32_dpp v96, v82, v80 row_ror:8 row_mask:0xf bank_mask:0x3
    v_add_f32_dpp v96, v81, v83 row_ror:8 row_mask:0xf bank_mask:0xc
    v_add_f32_dpp v98, v86, v84 row_ror:8 row_mask:0xf bank_mask:0x3
    v_add_f32_dpp v98, v85, v87 row_ror:8 row_mask:0xf bank_mask:0xc
    v_add_f32_dpp v100, v90, v88 row_ror:8 row_mask:0xf bank_mask:0x3
    v_add_f32_dpp v100, v89, v91 row_ror:8 row_mask:0xf bank_mask:0xc
    v_add_f32_dpp v102, v94, v92 row_ror:8 row_mask:0xf bank_mask:0x3
    v_add_f32_dpp v102, v93, v95 row_ror:8 row_mask:0xf bank_mask:0xc
    v_lshlrev_b32 v3, 13, v3
    v_lshl_add_u32 v3, v6, 5, v3
    s_lshl_b32 s52, s29, 4
    s_add_u32 s53, s52, s30
    s_lshl_b32 s53, s53, 10
    s_lshl_b32 s54, s34, 8
    s_add_u32 s53, s53, s54
    s_add_u32 s53, s53, 65536
    s_mov_b64 exec, 0xffff
    buffer_store_dwordx4 v[96:99], v3, s[36:39], s53 offen sc1
    buffer_store_dwordx4 v[100:103], v3, s[36:39], s53 offen offset:16 sc1
    s_mov_b64 exec, -1
    v_lshrrev_b32 v3, 3, v0
    v_lshlrev_b32 v3, 10, v3
    v_and_b32 v4, 7, v0
    v_lshl_add_u32 v3, v4, 5, v3
    s_lshl_b32 s53, s31, 3
    s_add_u32 s53, s53, s52
    s_lshl_b32 s53, s53, 10
    s_add_u32 s53, s53, s54
    s_add_u32 s53, s53, 65536
    s_cmp_lg_u32 s34, 0
    s_cbranch_scc1 L_noinit
    v_lshlrev_b32 v122, 4, v0
    v_mov_b32 v124, -1
    v_mov_b32 v125, -1
    v_mov_b32 v126, -1
    v_mov_b32 v127, -1
    s_lshl_b32 s56, s2, 10
    s_add_u32 s56, s56, 589824
    buffer_store_dwordx4 v[124:127], v122, s[36:39], s56 offen sc1
    v_lshlrev_b32 v123, 3, v0
    s_lshl_b32 s56, s2, 9
    s_add_u32 s56, s56, 851968
    buffer_store_dwordx2 v[124:125], v123, s[36:39], s56 offen sc1
    s_lshl_b32 s56, s69, 12
    s_add_u32 s56, s56, 1048576
    s_lshl_b32 s57, s66, 12
    s_add_u32 s57, s57, 1769472
    s_cmp_eq_u32 s67, 2
    s_cselect_b32 s56, s57, s56
    s_cmp_eq_u32 s67, 0
    s_cselect_b32 s56, 3145728, s56
    buffer_store_dwordx4 v[124:127], v122, s[36:39], s56 offen offset:0 sc1
    buffer_store_dwordx4 v[124:127], v122, s[36:39], s56 offen offset:1024 sc1
    buffer_store_dwordx4 v[124:127], v122, s[36:39], s56 offen offset:2048 sc1
    buffer_store_dwordx4 v[124:127], v122, s[36:39], s56 offen offset:3072 sc1
    v_lshlrev_b32 v123, 2, v0
    v_mov_b32 v121, 0
    s_lshl_b32 s57, s33, 8
    s_add_u32 s57, s57, 4096
    s_cmp_eq_u32 s32, 0
    s_cselect_b32 s56, s57, 3145728
    s_mov_b64 exec, 1
    buffer_store_dword v121, v123, s[36:39], s56 offen sc1
    s_getreg_b32 s57, hwreg(HW_REG_XCC_ID)
    s_lshl_b32 s56, s2, 2
    s_add_u32 s56, s56, 32768
    v_mov_b32 v120, s57
    buffer_store_dword v120, v123, s[36:39], s56 offen sc1
    s_mov_b64 exec, -1
L_noinit:
    s_sleep 40
    buffer_load_dwordx4 v[128:131], v3, s[36:39], s53 offen sc1
    buffer_load_dwordx4 v[132:135], v3, s[36:39], s53 offen offset:16 sc1
    s_mov_b32 s55, 16384
L_qpoll:
    s_waitcnt vmcnt(0)
    v_xor_b32 v5, s35, v129
    v_xor_b32 v6, s35, v131
    v_xor_b32 v7, s35, v133
    v_xor_b32 v8, s35, v135
    v_or3_b32 v5, v5, v6, v7
    v_or_b32 v5, v5, v8
    v_cmp_ne_u32 vcc, 0, v5
    s_cbranch_vccz L_qok0
    buffer_load_dwordx4 v[128:131], v3, s[36:39], s53 offen sc1
    buffer_load_dwordx4 v[132:135], v3, s[36:39], s53 offen offset:16 sc1
    s_sub_u32 s55, s55, 1
    s_cbranch_scc0 L_qpoll
L_qok0:
    v_mov_b32 v104, v128
    v_mov_b32 v106, v130
    v_mov_b32 v108, v132
    v_mov_b32 v110, v134
L_qok:
    s_setprio 0
    s_mov_b32 s48, s24
    s_mov_b32 s49, s25
    s_mov_b32 s50, 256
    s_mov_b32 s51, 0x20000
    s_cmp_lg_u32 s34, 0
    s_cbranch_scc1 L_nocnt
    v_mov_b32 v16, 1
    s_mov_b64 exec, 1
    buffer_atomic_add v16, off, s[48:51], 0 sc1
    s_mov_b64 exec, -1
L_nocnt:
    v_permlane32_swap_b32 v104, v108
    v_permlane32_swap_b32 v106, v110
    v_add_f32 v104, v104, v108
    v_add_f32 v106, v106, v110
    s_nop 1
    v_permlane16_swap_b32 v104, v106
    v_add_f32 v104, v104, v106
    s_nop 1
    v_add_f32_dpp v105, v104, v104 row_ror:8 row_mask:0xf bank_mask:0xf
    v_cvt_pk_bf16_f32 v105, v105, v105
    v_lshl_add_u32 v4, v4, 2, v1
    s_lshl_b32 s54, s34, 5
    v_add_u32 v4, s54, v4
    v_lshlrev_b32 v4, 1, v4
    ds_write_b16 v4, v105 offset:0
    s_waitcnt lgkmcnt(0)
    s_barrier
    s_cmp_lg_u32 s34, 0
    s_cbranch_scc1 L_noflag
    s_mov_b32 s55, 16384
    v_mov_b32 v17, 260
L_gospin:
    ds_read_b32 v16, v17
    s_waitcnt lgkmcnt(0)
    v_readfirstlane_b32 s52, v16
    s_cmp_eq_u32 s52, 1
    s_cbranch_scc1 L_gook
    s_sleep 16
    s_sub_u32 s55, s55, 1
    s_cbranch_scc0 L_gospin
L_gook:
    s_mov_b32 s55, 16384
L_cntpoll:
    buffer_load_dword v16, off, s[48:51], 0 sc1
    s_waitcnt vmcnt(0)
    v_readfirstlane_b32 s52, v16
    s_cmp_ge_u32 s52, 256
    s_cbranch_scc1 L_cntok
    s_sleep 64
    s_sub_u32 s55, s55, 1
    s_cbranch_scc0 L_cntpoll
L_cntok:
    v_mov_b32 v16, 1
    v_mov_b32 v17, 256
    ds_write_b32 v17, v16
    s_lshl_b32 s53, s30, 2
    s_add_u32 s53, s53, 32768
    v_and_b32 v17, 31, v0
    v_lshlrev_b32 v17, 5, v17
    buffer_load_dword v16, v17, s[36:39], s53 offen sc1
    s_getreg_b32 s54, hwreg(HW_REG_XCC_ID)
    s_waitcnt vmcnt(0)
    v_cmp_ne_u32 vcc, s54, v16
    s_cmp_ge_u32 s52, 256
    s_cselect_b32 s49, 1, 0
    s_cmp_eq_u64 vcc, 0
    s_cselect_b32 s49, s49, 0
    v_mov_b32 v16, 1
    v_mov_b32 v17, 256
    ds_write_b32 v17, v16
    s_waitcnt lgkmcnt(0)
L_noflag:
    s_mov_b32 s44, s12
    s_mov_b32 s45, s13
    s_mov_b32 s46, 0x400000
    s_mov_b32 s47, 0x20000
    v_lshlrev_b32 v3, 13, v1
    v_lshl_add_u32 v3, v2, 3, v3
    s_lshl_b32 s52, s29, 17
    s_lshl_b32 s53, s34, 15
    s_add_u32 s52, s52, s53
    s_lshl_b32 s53, s30, 7
    s_add_u32 s52, s52, s53
    s_add_u32 s53, s52, 4096
    buffer_load_dwordx2 v[16:17], v3, s[44:47], s52 offen offset:0 nt
    buffer_load_dwordx2 v[18:19], v3, s[44:47], s52 offen offset:1024 nt
    buffer_load_dwordx2 v[20:21], v3, s[44:47], s52 offen offset:2048 nt
    buffer_load_dwordx2 v[22:23], v3, s[44:47], s52 offen offset:3072 nt
    buffer_load_dwordx2 v[24:25], v3, s[44:47], s53 offen offset:0 nt
    buffer_load_dwordx2 v[26:27], v3, s[44:47], s53 offen offset:1024 nt
    buffer_load_dwordx2 v[28:29], v3, s[44:47], s53 offen offset:2048 nt
    buffer_load_dwordx2 v[30:31], v3, s[44:47], s53 offen offset:3072 nt
    v_and_b32 v5, 7, v0
    v_bfe_u32 v4, v0, 3, 1
    v_lshl_add_u32 v65, v5, 2, v1
    v_lshl_add_u32 v65, v4, 5, v65
    v_lshlrev_b32 v65, 2, v65
    v_bfe_u32 v8, v2, 2, 1
    s_add_u32 s72, s26, 1769472
    s_addc_u32 s73, s27, 0
    s_mov_b32 s74, 176128
    s_mov_b32 s75, 0x20000
    s_cmp_eq_u32 s67, 1
    s_cbranch_scc1 L_pf_gu
    s_cmp_eq_u32 s67, 2
    s_cbranch_scc1 L_pf_down
    s_waitcnt vmcnt(0)
    v_perm_b32 v112, v18, v16, s64
    v_perm_b32 v113, v22, v20, s64
    v_perm_b32 v114, v26, v24, s64
    v_perm_b32 v115, v30, v28, s64
    v_perm_b32 v116, v18, v16, s65
    v_perm_b32 v117, v22, v20, s65
    v_perm_b32 v118, v26, v24, s65
    v_perm_b32 v119, v30, v28, s65
    v_perm_b32 v120, v19, v17, s64
    v_perm_b32 v121, v23, v21, s64
    v_perm_b32 v122, v27, v25, s64
    v_perm_b32 v123, v31, v29, s64
    v_perm_b32 v124, v19, v17, s65
    v_perm_b32 v125, v23, v21, s65
    v_perm_b32 v126, v27, v25, s65
    v_perm_b32 v127, v31, v29, s65
    s_branch L_pf_done
L_pf_gu:
    s_cmp_lt_u32 s34, 2
    s_cselect_b32 s40, s16, s18
    s_cselect_b32 s41, s17, s19
    s_mov_b32 s42, 1409024
    s_mov_b32 s43, 0x20000
    s_mov_b32 s52, 2752*8
    v_mul_lo_u32 v6, v1, s52
    v_lshl_add_u32 v6, v2, 3, v6
    s_mul_i32 s52, s68, 88064
    s_lshl_b32 s53, s66, 8
    s_add_u32 s52, s52, s53
    s_and_b32 s54, s34, 1
    s_lshl_b32 s53, s54, 7
    s_add_u32 s52, s52, s53
    buffer_load_dwordx2 v[144:145], v6, s[40:43], s52 offen offset:0 nt
    buffer_load_dwordx2 v[146:147], v6, s[40:43], s52 offen offset:2752 nt
    s_add_u32 s52, s52, 5504
    buffer_load_dwordx2 v[148:149], v6, s[40:43], s52 offen offset:0 nt
    buffer_load_dwordx2 v[150:151], v6, s[40:43], s52 offen offset:2752 nt
    s_add_u32 s52, s52, 5504
    buffer_load_dwordx2 v[152:153], v6, s[40:43], s52 offen offset:0 nt
    buffer_load_dwordx2 v[154:155], v6, s[40:43], s52 offen offset:2752 nt
    s_add_u32 s52, s52, 5504
    buffer_load_dwordx2 v[156:157], v6, s[40:43], s52 offen offset:0 nt
    buffer_load_dwordx2 v[158:159], v6, s[40:43], s52 offen offset:2752 nt
    s_mov_b32 s44, s4
    s_mov_b32 s45, s5
    s_mov_b32 s46, 2048
    s_mov_b32 s47, 0x20000
    v_lshlrev_b32 v9, 10, v8
    v_lshl_add_u32 v9, v1, 4, v9
    s_lshl_b32 s52, s68, 6
    buffer_load_dwordx4 v[88:91], v9, s[44:47], s52 offen
    v_lshrrev_b32 v9, 3, v0
    v_lshlrev_b32 v9, 12, v9
    v_lshl_add_u32 v64, v5, 4, v9
    s_lshl_b32 s56, s34, 15
    s_lshr_b32 s52, s68, 1
    s_lshl_b32 s52, s52, 9
    s_add_u32 s56, s56, s52
    s_and_b32 s52, s68, 1
    s_lshl_b32 s52, s52, 7
    s_add_u32 s56, s56, s52
    s_add_u32 s56, s56, 851968
    v_lshlrev_b32 v9, 7, v8
    v_lshl_add_u32 v66, v1, 5, v9
    v_lshlrev_b32 v9, 9, v1
    v_lshl_add_u32 v67, v2, 4, v9
    s_lshl_b32 s58, s69, 12
    s_add_u32 s58, s58, 1048576
    s_lshr_b32 s52, s34, 1
    s_mul_i32 s52, s52, 1536
    s_add_u32 s57, s58, s52
    s_lshl_b32 s52, s54, 8
    s_add_u32 s57, s57, s52
    v_lshrrev_b32 v9, 1, v1
    v_lshl_add_u32 v9, v9, 1, v8
    v_lshlrev_b32 v9, 2, v9
    v_add_u32 v68, 3072, v9
    v_mov_b32 v70, 0x3f803f80
    s_lshl_b32 s52, s34, 8
    v_add_u32 v65, s52, v65
    s_mov_b32 s70, 0x0f000f00
    s_mov_b32 s71, 0x0f000f00
    v_lshlrev_b32 v9, 14, v1
    v_lshl_add_u32 v9, v4, 11, v9
    v_lshl_add_u32 v69, v5, 4, v9
    s_lshl_b32 s59, s34, 12
    s_lshl_b32 s52, s68, 7
    s_add_u32 s59, s59, s52
    s_add_u32 s60, s59, 65536
    s_add_u32 s61, s59, 131072
    v_lshlrev_b32 v71, 2, v0
    v_lshlrev_b32 v72, 1, v0
    v_lshrrev_b32 v9, 5, v0
    v_lshlrev_b32 v9, 10, v9
    v_and_b32 v10, 31, v0
    v_lshl_add_u32 v73, v10, 1, v9
    v_lshlrev_b32 v9, 6, v8
    v_lshl_add_u32 v74, v1, 4, v9
    s_lshl_b32 s62, s68, 6
    s_mov_b32 s44, s22
    s_mov_b32 s45, s23
    s_mov_b32 s46, 2048
    s_mov_b32 s47, 0x20000
    s_waitcnt vmcnt(9)
    v_perm_b32 v112, v18, v16, s64
    v_perm_b32 v113, v22, v20, s64
    v_perm_b32 v114, v26, v24, s64
    v_perm_b32 v115, v30, v28, s64
    v_perm_b32 v116, v18, v16, s65
    v_perm_b32 v117, v22, v20, s65
    v_perm_b32 v118, v26, v24, s65
    v_perm_b32 v119, v30, v28, s65
    v_perm_b32 v120, v19, v17, s64
    v_perm_b32 v121, v23, v21, s64
    v_perm_b32 v122, v27, v25, s64
    v_perm_b32 v123, v31, v29, s64
    v_perm_b32 v124, v19, v17, s65
    v_perm_b32 v125, v23, v21, s65
    v_perm_b32 v126, v27, v25, s65
    v_perm_b32 v127, v31, v29, s65
    s_waitcnt vmcnt(1)
    v_perm_b32 v128, v146, v144, s64
    v_perm_b32 v129, v150, v148, s64
    v_perm_b32 v130, v154, v152, s64
    v_perm_b32 v131, v158, v156, s64
    v_perm_b32 v132, v146, v144, s65
    v_perm_b32 v133, v150, v148, s65
    v_perm_b32 v134, v154, v152, s65
    v_perm_b32 v135, v158, v156, s65
    v_perm_b32 v136, v147, v145, s64
    v_perm_b32 v137, v151, v149, s64
    v_perm_b32 v138, v155, v153, s64
    v_perm_b32 v139, v159, v157, s64
    v_perm_b32 v140, v147, v145, s65
    v_perm_b32 v141, v151, v149, s65
    v_perm_b32 v142, v155, v153, s65
    v_perm_b32 v143, v159, v157, s65
    s_waitcnt vmcnt(0)
    v_lshlrev_b32 v80, 16, v88
    v_and_b32 v81, 0xffff0000, v88
    v_lshlrev_b32 v82, 16, v89
    v_and_b32 v83, 0xffff0000, v89
    v_lshlrev_b32 v84, 16, v90
    v_and_b32 v85, 0xffff0000, v90
    v_lshlrev_b32 v86, 16, v91
    v_and_b32 v87, 0xffff0000, v91
    s_branch L_pf_done
L_pf_down:
    s_mov_b32 s40, s20
    s_mov_b32 s41, s21
    s_mov_b32 s42, 1409024
    s_mov_b32 s43, 0x20000
    v_lshlrev_b32 v6, 13, v1
    v_lshl_add_u32 v6, v2, 4, v6
    s_lshl_b32 s52, s66, 15
    s_lshl_b32 s53, s34, 8
    s_add_u32 s52, s52, s53
    s_add_u32 s53, s52, 4096
    buffer_load_dwordx4 v[160:163], v6, s[40:43], s52 offen offset:0 nt
    buffer_load_dwordx4 v[164:167], v6, s[40:43], s52 offen offset:1024 nt
    buffer_load_dwordx4 v[168:171], v6, s[40:43], s52 offen offset:2048 nt
    buffer_load_dwordx4 v[172:175], v6, s[40:43], s52 offen offset:3072 nt
    buffer_load_dwordx4 v[176:179], v6, s[40:43], s53 offen offset:0 nt
    buffer_load_dwordx4 v[180:183], v6, s[40:43], s53 offen offset:1024 nt
    buffer_load_dwordx4 v[184:187], v6, s[40:43], s53 offen offset:2048 nt
    buffer_load_dwordx4 v[188:191], v6, s[40:43], s53 offen offset:3072 nt
    v_lshlrev_b32 v9, 12, v2
    v_add_u32 v68, 3072, v9
    v_lshlrev_b32 v9, 12, v1
    s_mov_b32 s52, 1536
    v_mul_lo_u32 v10, v4, s52
    v_add_u32 v9, v9, v10
    v_lshl_add_u32 v64, v5, 4, v9
    s_lshr_b32 s52, s66, 2
    s_lshl_b32 s52, s52, 4
    s_lshl_b32 s53, s34, 2
    s_add_u32 s52, s52, s53
    s_lshl_b32 s52, s52, 12
    s_add_u32 s58, s52, 1048576
    s_and_b32 s52, s66, 3
    s_lshl_b32 s52, s52, 7
    s_add_u32 s56, s58, s52
    s_lshr_b32 s52, s66, 2
    s_lshl_b32 s52, s52, 16
    s_add_u32 s58, s52, 1048576
    v_and_b32 v10, 31, v0
    v_lshlrev_b32 v10, 2, v10
    v_lshrrev_b32 v11, 5, v0
    v_lshl_add_u32 v66, v11, 8, v10
    v_add_u32 v70, 128, v66
    v_add_u32 v69, 512, v10
    v_add_u32 v74, 640, v10
    s_mul_i32 s52, s34, 768
    v_add_u32 v65, s52, v65
    s_lshl_b32 s52, s34, 7
    s_add_u32 s52, s52, 6400
    v_lshlrev_b32 v9, 1, v0
    v_add_u32 v71, s52, v9
    v_lshlrev_b32 v9, 6, v8
    v_lshl_add_u32 v9, v1, 4, v9
    v_add_u32 v72, s52, v9
    v_and_b32 v9, 1, v1
    v_lshlrev_b32 v9, 11, v9
    v_lshl_add_u32 v9, v2, 5, v9
    v_lshrrev_b32 v10, 1, v1
    v_lshl_add_u32 v67, v10, 4, v9
    s_lshl_b32 s57, s66, 12
    s_lshl_b32 s52, s34, 9
    s_add_u32 s57, s57, s52
    s_add_u32 s57, s57, 1769472
    s_waitcnt vmcnt(8)
    v_perm_b32 v112, v18, v16, s64
    v_perm_b32 v113, v22, v20, s64
    v_perm_b32 v114, v26, v24, s64
    v_perm_b32 v115, v30, v28, s64
    v_perm_b32 v116, v18, v16, s65
    v_perm_b32 v117, v22, v20, s65
    v_perm_b32 v118, v26, v24, s65
    v_perm_b32 v119, v30, v28, s65
    v_perm_b32 v120, v19, v17, s64
    v_perm_b32 v121, v23, v21, s64
    v_perm_b32 v122, v27, v25, s64
    v_perm_b32 v123, v31, v29, s64
    v_perm_b32 v124, v19, v17, s65
    v_perm_b32 v125, v23, v21, s65
    v_perm_b32 v126, v27, v25, s65
    v_perm_b32 v127, v31, v29, s65
    s_waitcnt vmcnt(0)
    v_perm_b32 v128, v164, v160, s64
    v_perm_b32 v129, v172, v168, s64
    v_perm_b32 v130, v180, v176, s64
    v_perm_b32 v131, v188, v184, s64
    v_perm_b32 v132, v164, v160, s65
    v_perm_b32 v133, v172, v168, s65
    v_perm_b32 v134, v180, v176, s65
    v_perm_b32 v135, v188, v184, s65
    v_perm_b32 v136, v165, v161, s64
    v_perm_b32 v137, v173, v169, s64
    v_perm_b32 v138, v181, v177, s64
    v_perm_b32 v139, v189, v185, s64
    v_perm_b32 v140, v165, v161, s65
    v_perm_b32 v141, v173, v169, s65
    v_perm_b32 v142, v181, v177, s65
    v_perm_b32 v143, v189, v185, s65
    v_perm_b32 v144, v166, v162, s64
    v_perm_b32 v145, v174, v170, s64
    v_perm_b32 v146, v182, v178, s64
    v_perm_b32 v147, v190, v186, s64
    v_perm_b32 v148, v166, v162, s65
    v_perm_b32 v149, v174, v170, s65
    v_perm_b32 v150, v182, v178, s65
    v_perm_b32 v151, v190, v186, s65
    v_perm_b32 v152, v167, v163, s64
    v_perm_b32 v153, v175, v171, s64
    v_perm_b32 v154, v183, v179, s64
    v_perm_b32 v155, v191, v187, s64
    v_perm_b32 v156, v167, v163, s65
    v_perm_b32 v157, v175, v171, s65
    v_perm_b32 v158, v183, v179, s65
    v_perm_b32 v159, v191, v187, s65
L_pf_done:
    s_cmp_lg_u32 s34, 1
    s_cbranch_scc1 L_svc_end
    s_mov_b32 s84, 262144
    v_mov_b32 v246, 256
L_svc_wf:
    ds_read_b32 v247, v246
    s_waitcnt lgkmcnt(0)
    v_readfirstlane_b32 s85, v247
    s_cmp_lg_u32 s85, 0
    s_cbranch_scc1 L_svc_okf
    s_sleep 4
    s_sub_u32 s84, s84, 1
    s_cbranch_scc0 L_svc_wf
L_svc_okf:
    s_mov_b32 s84, 262144
    v_mov_b32 v246, 268
L_svc_wg:
    ds_read_b32 v247, v246
    s_waitcnt lgkmcnt(0)
    v_readfirstlane_b32 s85, v247
    s_cmp_lg_u32 s85, 0
    s_cbranch_scc1 L_svc_okg
    s_sleep 4
    s_sub_u32 s84, s84, 1
    s_cbranch_scc0 L_svc_wg
L_svc_okg:
    s_lshl_b32 s86, s33, 8
    s_add_u32 s86, s86, 4096
    v_mov_b32 v245, s86
    v_mov_b32 v246, 264
    s_mov_b32 s86, 0
    s_mov_b32 s84, 1048576
L_svc:
    ds_read_b32 v247, v246
    s_waitcnt lgkmcnt(0)
    v_readfirstlane_b32 s85, v247
    s_add_u32 s85, s85, 8
    s_sub_i32 s85, s85, s86
    s_cmp_gt_i32 s85, 0
    s_cbranch_scc1 L_svc_claim
    s_sleep 2
    s_sub_u32 s84, s84, 1
    s_cbranch_scc0 L_svc
    s_branch L_svc_fill
L_svc_claim:
    s_max_u32 s85, s85, 4
    s_min_u32 s85, s85, 16
    v_mov_b32 v247, s85
    s_mov_b64 exec, 1
    buffer_atomic_add v247, v245, s[36:39], 0 offen sc0 sc1
    s_mov_b64 exec, -1
    s_waitcnt vmcnt(0)
    v_readfirstlane_b32 s87, v247
    s_bfm_b64 exec, s85, 0
    s_add_u32 s88, s87, 384
    v_add_u32 v247, s88, v0
    v_add_u32 v248, s86, v0
    v_lshlrev_b32 v248, 2, v248
    ds_write_b32 v248, v247 offset:13312
    s_mov_b64 exec, -1
    s_add_u32 s86, s86, s85
    s_add_u32 s87, s87, s85
    s_cmp_lt_u32 s87, 128
    s_cbranch_scc1 L_svc
L_svc_fill:
    v_mov_b32 v247, 0x10000
    v_add_u32 v248, s86, v0
    v_add_u32 v248, 0, v248
    v_cmp_gt_u32 vcc, 256, v248
    s_and_b64 exec, vcc, -1
    v_lshlrev_b32 v248, 2, v248
    ds_write_b32 v248, v247 offset:13312
    s_mov_b64 exec, -1
    v_add_u32 v248, s86, v0
    v_add_u32 v248, 64, v248
    v_cmp_gt_u32 vcc, 256, v248
    s_and_b64 exec, vcc, -1
    v_lshlrev_b32 v248, 2, v248
    ds_write_b32 v248, v247 offset:13312
    s_mov_b64 exec, -1
    v_add_u32 v248, s86, v0
    v_add_u32 v248, 128, v248
    v_cmp_gt_u32 vcc, 256, v248
    s_and_b64 exec, vcc, -1
    v_lshlrev_b32 v248, 2, v248
    ds_write_b32 v248, v247 offset:13312
    s_mov_b64 exec, -1
    v_add_u32 v248, s86, v0
    v_add_u32 v248, 192, v248
    v_cmp_gt_u32 vcc, 256, v248
    s_and_b64 exec, vcc, -1
    v_lshlrev_b32 v248, 2, v248
    ds_write_b32 v248, v247 offset:13312
    s_mov_b64 exec, -1
    s_waitcnt lgkmcnt(0)
L_svc_end:
    v_bfe_u32 v6, v2, 1, 1
    v_and_b32 v7, 1, v2
    v_lshl_or_b32 v6, v7, 1, v6
    v_and_b32 v7, 4, v2
    v_or_b32 v6, v6, v7
    v_lshlrev_b32 v6, 10, v6
    v_lshl_add_u32 v7, v1, 5, v6
    s_lshl_b32 s52, s29, 13
    s_add_u32 s52, s52, 589824
    s_lshl_b32 s53, s34, 7
    s_add_u32 s53, s53, s52
    s_mov_b32 s55, 16384
    s_waitcnt lgkmcnt(0)
    s_barrier
L_opoll:
    buffer_load_dwordx4 v[16:19], v7, s[36:39], s53 offen sc1
    buffer_load_dwordx4 v[20:23], v7, s[36:39], s53 offen offset:16 sc1
    buffer_load_dwordx2 v[24:25], v6, s[36:39], s52 offen offset:512 sc1
    s_waitcnt vmcnt(0)
    v_max3_u32 v12, v16, v17, v18
    v_max3_u32 v13, v19, v20, v21
    v_max3_u32 v12, v12, v22, v23
    v_max3_u32 v13, v13, v24, v25
    v_max_u32 v12, v12, v13
    v_cmp_eq_u32 vcc, -1, v12
    s_sub_u32 s55, s55, 1
    s_cbranch_scc1 L_opoll_out
    s_mov_b64 exec, vcc
    s_cbranch_execnz L_opoll
L_opoll_out:
    s_mov_b64 exec, -1
    v_max_f32_dpp v12, v24, v24 quad_perm:[2,3,0,1] row_mask:0xf bank_mask:0xf
    s_nop 1
    v_max_f32_dpp v13, v12, v12 row_ror:4 row_mask:0xf bank_mask:0xf
    v_sub_f32 v12, v24, v13
    v_exp_f32 v12, v12
    s_nop 0
    v_mul_f32 v13, v12, v25
    s_nop 1
    v_add_f32_dpp v14, v13, v13 quad_perm:[2,3,0,1] row_mask:0xf bank_mask:0xf
    s_nop 1
    v_add_f32_dpp v13, v14, v14 row_ror:4 row_mask:0xf bank_mask:0xf
    v_rcp_f32 v13, v13
    s_nop 0
    v_mul_f32 v12, v12, v13
    v_mul_f32 v16, v16, v12
    v_mul_f32 v17, v17, v12
    v_mul_f32 v18, v18, v12
    v_mul_f32 v19, v19, v12
    v_mul_f32 v20, v20, v12
    v_mul_f32 v21, v21, v12
    v_mul_f32 v22, v22, v12
    v_mul_f32 v23, v23, v12
    v_add_f32_dpp v32, v16, v16 quad_perm:[2,3,0,1] row_mask:0xf bank_mask:0xf
    v_add_f32_dpp v33, v17, v17 quad_perm:[2,3,0,1] row_mask:0xf bank_mask:0xf
    v_add_f32_dpp v34, v18, v18 quad_perm:[2,3,0,1] row_mask:0xf bank_mask:0xf
    v_add_f32_dpp v35, v19, v19 quad_perm:[2,3,0,1] row_mask:0xf bank_mask:0xf
    v_add_f32_dpp v36, v20, v20 quad_perm:[2,3,0,1] row_mask:0xf bank_mask:0xf
    v_add_f32_dpp v37, v21, v21 quad_perm:[2,3,0,1] row_mask:0xf bank_mask:0xf
    v_add_f32_dpp v38, v22, v22 quad_perm:[2,3,0,1] row_mask:0xf bank_mask:0xf
    v_add_f32_dpp v39, v23, v23 quad_perm:[2,3,0,1] row_mask:0xf bank_mask:0xf
    v_add_f32_dpp v16, v32, v32 row_ror:4 row_mask:0xf bank_mask:0xf
    v_add_f32_dpp v17, v33, v33 row_ror:4 row_mask:0xf bank_mask:0xf
    v_add_f32_dpp v18, v34, v34 row_ror:4 row_mask:0xf bank_mask:0xf
    v_add_f32_dpp v19, v35, v35 row_ror:4 row_mask:0xf bank_mask:0xf
    v_add_f32_dpp v20, v36, v36 row_ror:4 row_mask:0xf bank_mask:0xf
    v_add_f32_dpp v21, v37, v37 row_ror:4 row_mask:0xf bank_mask:0xf
    v_add_f32_dpp v22, v38, v38 row_ror:4 row_mask:0xf bank_mask:0xf
    v_add_f32_dpp v23, v39, v39 row_ror:4 row_mask:0xf bank_mask:0xf
    v_cvt_pk_bf16_f32 v28, v16, v17
    v_cvt_pk_bf16_f32 v29, v18, v19
    v_cvt_pk_bf16_f32 v30, v20, v21
    v_cvt_pk_bf16_f32 v31, v22, v23
    s_nop 1
    v_mfma_f32_16x16x32_bf16 v[32:35], v[28:31], v[112:115], 0
    v_mfma_f32_16x16x32_bf16 v[36:39], v[28:31], v[116:119], 0
    v_mfma_f32_16x16x32_bf16 v[40:43], v[28:31], v[120:123], 0
    v_mfma_f32_16x16x32_bf16 v[44:47], v[28:31], v[124:127], 0
    s_lshl_b32 s52, s34, 9
    s_add_u32 s52, s52, 2560
    v_lshlrev_b32 v13, 4, v2
    v_add_u32 v13, s52, v13
    s_mov_b64 exec, 0xffff
    s_nop 0
    ds_write2_b32 v13, v32, v36 offset0:0 offset1:1
    s_nop 0
    ds_write2_b32 v13, v40, v44 offset0:2 offset1:3
    ds_write2_b32 v13, v33, v37 offset0:64 offset1:65
    ds_write2_b32 v13, v41, v45 offset0:66 offset1:67
    s_mov_b64 exec, -1
    s_waitcnt lgkmcnt(0)
    s_barrier
    s_cmp_lg_u32 s34, 0
    s_cbranch_scc1 L_noY
    v_lshlrev_b32 v12, 4, v0
    s_mov_b64 exec, 0xffffffff
    ds_read_b128 v[16:19], v12 offset:2560
    ds_read_b128 v[20:23], v12 offset:3072
    ds_read_b128 v[24:27], v12 offset:3584
    ds_read_b128 v[28:31], v12 offset:4096
    s_lshl_b32 s52, s2, 9
    s_add_u32 s52, s52, 851968
    s_mov_b32 s63, 0xfffffffe
    s_waitcnt lgkmcnt(2)
    v_add_f32 v16, v16, v20
    v_add_f32 v17, v17, v21
    v_add_f32 v18, v18, v22
    v_add_f32 v19, v19, v23
    s_waitcnt lgkmcnt(0)
    v_add_f32 v24, v24, v28
    v_add_f32 v25, v25, v29
    v_add_f32 v26, v26, v30
    v_add_f32 v27, v27, v31
    v_add_f32 v16, v16, v24
    v_add_f32 v17, v17, v25
    v_add_f32 v18, v18, v26
    v_add_f32 v19, v19, v27
    v_min_u32 v16, s63, v16
    v_min_u32 v17, s63, v17
    v_min_u32 v18, s63, v18
    v_min_u32 v19, s63, v19
    s_cmp_eq_u32 s49, 1
    s_cbranch_scc1 L_ypubf
    buffer_store_dwordx4 v[16:19], v12, s[36:39], s52 offen sc1
    s_branch L_ypubd
L_ypubf:
    buffer_store_dwordx4 v[16:19], v12, s[36:39], s52 offen
L_ypubd:
    s_mov_b64 exec, -1
L_noY:
    s_cmp_eq_u32 s67, 1
    s_cbranch_scc1 L_gu
    s_cmp_eq_u32 s67, 2
    s_cbranch_scc1 L_down
    s_branch L_hend
L_gu:
    s_mov_b32 s55, 16384
L_ypoll:
    buffer_load_dwordx4 v[96:99], v64, s[36:39], s56 offen offset:0 sc1
    buffer_load_dwordx4 v[100:103], v64, s[36:39], s56 offen offset:256 sc1
    s_waitcnt vmcnt(0)
    v_max3_u32 v12, v96, v97, v98
    v_max3_u32 v13, v99, v100, v101
    v_max3_u32 v12, v12, v102, v103
    v_max_u32 v12, v12, v13
    v_cmp_eq_u32 vcc, -1, v12
    s_sub_u32 s55, s55, 1
    s_cbranch_scc1 L_ypoll_out
    s_mov_b64 exec, vcc
    s_cbranch_execnz L_ypoll
L_ypoll_out:
    s_mov_b64 exec, -1
    v_add_f32_dpp v32, v96, v96 row_ror:8 row_mask:0xf bank_mask:0x3
    v_add_f32_dpp v32, v100, v100 row_ror:8 row_mask:0xf bank_mask:0xc
    v_add_f32_dpp v33, v97, v97 row_ror:8 row_mask:0xf bank_mask:0x3
    v_add_f32_dpp v33, v101, v101 row_ror:8 row_mask:0xf bank_mask:0xc
    v_add_f32_dpp v34, v98, v98 row_ror:8 row_mask:0xf bank_mask:0x3
    v_add_f32_dpp v34, v102, v102 row_ror:8 row_mask:0xf bank_mask:0xc
    v_add_f32_dpp v35, v99, v99 row_ror:8 row_mask:0xf bank_mask:0x3
    v_add_f32_dpp v35, v103, v103 row_ror:8 row_mask:0xf bank_mask:0xc
    v_permlane16_swap_b32 v32, v33
    s_nop 0
    v_permlane16_swap_b32 v34, v35
    v_add_f32 v32, v32, v33
    v_add_f32 v34, v34, v35
    s_nop 1
    v_permlane32_swap_b32 v32, v34
    v_add_f32 v32, v32, v34
    ds_write_b32 v65, v32 offset:8192
    s_mov_b32 s63, 0xfffffffe
    s_waitcnt lgkmcnt(0)
    s_barrier
    ds_read_b128 v[40:43], v66 offset:8192
    ds_read_b128 v[96:99], v66 offset:8448
    ds_read_b128 v[104:107], v66 offset:8704
    ds_read_b128 v[16:19], v66 offset:8960
    ds_read_b128 v[44:47], v66 offset:8208
    ds_read_b128 v[100:103], v66 offset:8464
    ds_read_b128 v[108:111], v66 offset:8720
    ds_read_b128 v[20:23], v66 offset:8976
    s_waitcnt lgkmcnt(4)
    v_pk_add_f32 v[40:41], v[40:41], v[96:97]
    v_pk_add_f32 v[42:43], v[42:43], v[98:99]
    v_pk_add_f32 v[104:105], v[104:105], v[16:17]
    v_pk_add_f32 v[106:107], v[106:107], v[18:19]
    v_pk_add_f32 v[40:41], v[40:41], v[104:105]
    v_pk_add_f32 v[42:43], v[42:43], v[106:107]
    v_cvt_pk_bf16_f32 v32, v40, v41
    v_cvt_pk_bf16_f32 v33, v42, v43
    v_lshlrev_b32 v40, 16, v32
    v_and_b32 v41, 0xffff0000, v32
    v_lshlrev_b32 v42, 16, v33
    v_and_b32 v43, 0xffff0000, v33
    v_add_f32 v40, v40, v80
    v_add_f32 v41, v41, v81
    v_add_f32 v42, v42, v82
    v_add_f32 v43, v43, v83
    v_cvt_pk_bf16_f32 v52, v40, v41
    v_cvt_pk_bf16_f32 v53, v42, v43
    v_cndmask_b32 v48, v52, v70, s[70:71]
    v_cndmask_b32 v49, v53, v70, s[70:71]
    s_waitcnt lgkmcnt(0)
    v_pk_add_f32 v[44:45], v[44:45], v[100:101]
    v_pk_add_f32 v[46:47], v[46:47], v[102:103]
    v_pk_add_f32 v[108:109], v[108:109], v[20:21]
    v_pk_add_f32 v[110:111], v[110:111], v[22:23]
    v_pk_add_f32 v[44:45], v[44:45], v[108:109]
    v_pk_add_f32 v[46:47], v[46:47], v[110:111]
    v_cvt_pk_bf16_f32 v34, v44, v45
    v_cvt_pk_bf16_f32 v35, v46, v47
    v_lshlrev_b32 v44, 16, v34
    v_and_b32 v45, 0xffff0000, v34
    v_lshlrev_b32 v46, 16, v35
    v_and_b32 v47, 0xffff0000, v35
    v_add_f32 v44, v44, v84
    v_add_f32 v45, v45, v85
    v_add_f32 v46, v46, v86
    v_add_f32 v47, v47, v87
    v_cvt_pk_bf16_f32 v54, v44, v45
    v_cvt_pk_bf16_f32 v55, v46, v47
    v_cndmask_b32 v50, v54, v70, s[70:71]
    v_cndmask_b32 v51, v55, v70, s[70:71]
    s_nop 1
    v_mfma_f32_16x16x32_bf16 v[16:19], v[48:51], v[128:131], 0
    v_mfma_f32_16x16x32_bf16 v[20:23], v[48:51], v[132:135], 0
    v_mfma_f32_16x16x32_bf16 v[24:27], v[48:51], v[136:139], 0
    v_mfma_f32_16x16x32_bf16 v[28:31], v[48:51], v[140:143], 0
    v_mfma_f32_16x16x32_bf16 v[56:59], v[48:51], v[48:51], 0
    s_nop 3
    v_min_u32 v60, s63, v16
    v_min_u32 v61, s63, v20
    v_min_u32 v62, s63, v24
    v_min_u32 v63, s63, v28
    s_mov_b32 s76, -1
    s_mov_b32 s77, 0xffff
    s_mov_b64 exec, s[76:77]
    buffer_store_dwordx4 v[60:63], v67, s[36:39], s57 offen sc1
    s_mov_b64 exec, -1
    s_cmp_lg_u32 s34, 0
    s_cbranch_scc1 L_gu_nostat
    v_min_u32 v56, s63, v56
    s_mov_b32 s76, 0x00100001
    s_mov_b32 s77, 0x11
    s_mov_b64 exec, s[76:77]
    buffer_store_dword v56, v68, s[36:39], s58 offen sc1
    s_mov_b32 s76, 0x00110011
    s_mov_b32 s77, 0x00110011
    s_mov_b64 exec, s[76:77]
    ds_write_b128 v74, v[52:55] offset:6144
    s_mov_b64 exec, -1
L_gu_nostat:
    s_cmp_lg_u32 s66, 0
    s_cbranch_scc1 L_hend
    s_mov_b32 s55, 16384
L_dpoll:
    buffer_load_dwordx4 v[96:99], v69, s[72:75], s59 offen sc1
    buffer_load_dwordx4 v[100:103], v69, s[72:75], s60 offen sc1
    buffer_load_dwordx4 v[104:107], v69, s[72:75], s61 offen sc1
    s_waitcnt vmcnt(0)
    v_max3_u32 v12, v96, v97, v98
    v_max3_u32 v13, v99, v100, v101
    v_max3_u32 v12, v12, v102, v103
    v_max3_u32 v13, v13, v104, v105
    v_max3_u32 v12, v12, v106, v107
    v_max_u32 v12, v12, v13
    v_cmp_eq_u32 vcc, -1, v12
    s_sub_u32 s55, s55, 1
    s_cbranch_scc1 L_dpoll_out
    s_mov_b64 exec, vcc
    s_cbranch_execnz L_dpoll
L_dpoll_out:
    s_mov_b64 exec, -1
    v_add_f32 v32, v96, v100
    v_add_f32 v33, v97, v101
    v_add_f32 v34, v98, v102
    v_add_f32 v35, v99, v103
    v_add_f32 v32, v32, v104
    v_add_f32 v33, v33, v105
    v_add_f32 v34, v34, v106
    v_add_f32 v35, v35, v107
    v_permlane16_swap_b32 v32, v33
    s_nop 0
    v_permlane16_swap_b32 v34, v35
    v_add_f32 v32, v32, v33
    v_add_f32 v34, v34, v35
    s_nop 1
    v_permlane32_swap_b32 v32, v34
    v_add_f32 v32, v32, v34
    ds_write_b32 v65, v32 offset:12288
    s_waitcnt lgkmcnt(0)
    s_barrier
    s_cmp_lg_u32 s34, 0
    s_cbranch_scc1 L_hend
    ds_read2st64_b32 v[32:33], v71 offset0:48 offset1:49
    ds_read2st64_b32 v[36:37], v71 offset0:50 offset1:51
    ds_read_u16 v40, v72 offset:6144
    s_waitcnt lgkmcnt(1)
    v_pk_add_f32 v[32:33], v[32:33], v[36:37]
    v_add_f32 v32, v32, v33
    s_waitcnt lgkmcnt(0)
    v_cvt_pk_bf16_f32 v32, v32, v32
    v_and_b32 v32, 0xffff0000, v32
    v_lshlrev_b32 v35, 16, v40
    v_add_f32 v32, v32, v35
    s_nop 1
    v_mov_b32_dpp v33, v32 quad_perm:[1,0,3,2] row_mask:0xf bank_mask:0xf
    v_cvt_pk_bf16_f32 v34, v32, v33
    s_mov_b32 s76, 0x55555555
    s_mov_b32 s77, 0x55555555
    s_mov_b64 exec, s[76:77]
    buffer_store_dword v34, v73, s[44:47], s62 offen
    s_cmp_lg_u32 s68, 0
    s_cbranch_scc1 L_noepoch
    v_mov_b32 v35, s35
    s_mov_b64 exec, 1
    buffer_store_dword v35, off, s[36:39], 0 offset:0 sc1
L_noepoch:
    s_mov_b64 exec, -1
    s_branch L_hend
L_down:
    s_mov_b32 s55, 16384
L_gpoll:
    buffer_load_dwordx4 v[96:99], v64, s[36:39], s56 offen offset:0 sc1
    buffer_load_dwordx4 v[100:103], v64, s[36:39], s56 offen offset:512 sc1
    buffer_load_dwordx4 v[104:107], v64, s[36:39], s56 offen offset:1024 sc1
    buffer_load_dwordx4 v[108:111], v68, s[36:39], s58 offen sc1
    s_waitcnt vmcnt(0)
    v_max3_u32 v12, v96, v97, v98
    v_max3_u32 v13, v99, v100, v101
    v_max3_u32 v12, v12, v102, v103
    v_max3_u32 v13, v13, v104, v105
    v_max3_u32 v12, v12, v106, v107
    v_max3_u32 v13, v13, v108, v109
    v_max3_u32 v12, v12, v110, v111
    v_max_u32 v12, v12, v13
    v_cmp_eq_u32 vcc, -1, v12
    s_sub_u32 s55, s55, 1
    s_cbranch_scc1 L_gpoll_out
    s_mov_b64 exec, vcc
    s_cbranch_execnz L_gpoll
L_gpoll_out:
    s_mov_b64 exec, -1
    v_permlane16_swap_b32 v96, v97
    v_permlane16_swap_b32 v98, v99
    v_permlane16_swap_b32 v100, v101
    v_permlane16_swap_b32 v102, v103
    v_permlane16_swap_b32 v104, v105
    v_permlane16_swap_b32 v106, v107
    v_add_f32 v96, v96, v97
    v_add_f32 v98, v98, v99
    v_add_f32 v100, v100, v101
    v_add_f32 v102, v102, v103
    v_add_f32 v104, v104, v105
    v_add_f32 v106, v106, v107
    v_permlane32_swap_b32 v96, v98
    v_permlane32_swap_b32 v100, v102
    v_permlane32_swap_b32 v104, v106
    v_add_f32 v96, v96, v98
    v_add_f32 v100, v100, v102
    v_add_f32 v104, v104, v106
    ds_write_b32 v65, v96 offset:9216
    ds_write_b32 v65, v100 offset:9472
    ds_write_b32 v65, v104 offset:9728
    s_mov_b32 s76, 0
    s_mov_b32 s77, -1
    v_cndmask_b32 v48, v108, v109, s[76:77]
    v_cndmask_b32 v49, v110, v111, s[76:77]
    s_mov_b32 s63, 0xfffffffe
    v_add_f32_dpp v50, v48, v48 row_ror:8 row_mask:0xf bank_mask:0xf
    v_add_f32_dpp v51, v49, v49 row_ror:8 row_mask:0xf bank_mask:0xf
    s_nop 0
    v_add_f32_dpp v48, v50, v50 row_ror:4 row_mask:0xf bank_mask:0xf
    v_add_f32_dpp v49, v51, v51 row_ror:4 row_mask:0xf bank_mask:0xf
    s_nop 0
    v_add_f32_dpp v50, v48, v48 row_ror:2 row_mask:0xf bank_mask:0xf
    v_add_f32_dpp v51, v49, v49 row_ror:2 row_mask:0xf bank_mask:0xf
    s_nop 0
    v_add_f32_dpp v48, v50, v50 row_ror:1 row_mask:0xf bank_mask:0xf
    v_add_f32_dpp v49, v51, v51 row_ror:1 row_mask:0xf bank_mask:0xf
    s_waitcnt lgkmcnt(0)
    s_barrier
    ds_read2st64_b32 v[16:17], v66 offset0:36 offset1:39
    ds_read2st64_b32 v[18:19], v66 offset0:42 offset1:45
    ds_read2st64_b32 v[20:21], v70 offset0:36 offset1:39
    ds_read2st64_b32 v[22:23], v70 offset0:42 offset1:45
    ds_read2st64_b32 v[24:25], v69 offset0:36 offset1:39
    ds_read2st64_b32 v[26:27], v69 offset0:42 offset1:45
    ds_read2st64_b32 v[28:29], v74 offset0:36 offset1:39
    ds_read2st64_b32 v[30:31], v74 offset0:42 offset1:45
    v_mul_f32 v49, 0x3b000000, v49
    v_mul_f32 v48, 0x3b000000, v48
    v_fma_f32 v48, -v49, v49, v48
    v_max_f32 v48, 0, v48
    v_cvt_pk_bf16_f32 v48, v48, v48
    v_and_b32 v48, 0xffff0000, v48
    v_add_f32 v48, 0x3727c5ac, v48
    v_cvt_pk_bf16_f32 v48, v48, v48
    v_and_b32 v48, 0xffff0000, v48
    v_sqrt_f32 v48, v48
    s_nop 0
    v_cvt_pk_bf16_f32 v48, v48, v48
    v_and_b32 v48, 0xffff0000, v48
    v_rcp_f32 v48, v48
    v_cvt_pk_bf16_f32 v49, v49, v49
    v_and_b32 v49, 0xffff0000, v49
    s_waitcnt lgkmcnt(6)
    v_pk_add_f32 v[16:17], v[16:17], v[18:19]
    v_add_f32 v32, v16, v17
    s_waitcnt lgkmcnt(4)
    v_pk_add_f32 v[20:21], v[20:21], v[22:23]
    v_add_f32 v33, v20, v21
    s_waitcnt lgkmcnt(2)
    v_pk_add_f32 v[24:25], v[24:25], v[26:27]
    v_add_f32 v34, v24, v25
    s_waitcnt lgkmcnt(0)
    v_pk_add_f32 v[28:29], v[28:29], v[30:31]
    v_add_f32 v35, v28, v29
    v_fma_f32 v32, -v49, v34, v32
    v_fma_f32 v33, -v49, v35, v33
    v_mul_f32 v32, v32, v48
    v_mul_f32 v33, v33, v48
    v_cvt_pk_bf16_f32 v36, v32, v33
    v_lshlrev_b32 v32, 16, v36
    v_and_b32 v33, 0xffff0000, v36
    v_max_f32 v32, 0, v32
    v_mul_f32 v32, v32, v33
    v_cvt_pk_bf16_f32 v36, v32, v32
    ds_write_b16 v71, v36
    ds_read_b128 v[48:51], v72
    s_waitcnt lgkmcnt(0)
    v_mfma_f32_16x16x32_bf16 v[16:19], v[48:51], v[128:131], 0
    v_mfma_f32_16x16x32_bf16 v[20:23], v[48:51], v[132:135], 0
    v_mfma_f32_16x16x32_bf16 v[24:27], v[48:51], v[136:139], 0
    v_mfma_f32_16x16x32_bf16 v[28:31], v[48:51], v[140:143], 0
    v_mfma_f32_16x16x32_bf16 v[32:35], v[48:51], v[144:147], 0
    v_mfma_f32_16x16x32_bf16 v[36:39], v[48:51], v[148:151], 0
    v_mfma_f32_16x16x32_bf16 v[40:43], v[48:51], v[152:155], 0
    v_mfma_f32_16x16x32_bf16 v[44:47], v[48:51], v[156:159], 0
    s_mov_b32 s76, 0
    s_mov_b32 s77, -1
    s_nop 2
    v_cndmask_b32 v60, v16, v32, s[76:77]
    v_cndmask_b32 v61, v20, v36, s[76:77]
    v_cndmask_b32 v62, v24, v40, s[76:77]
    v_cndmask_b32 v63, v28, v44, s[76:77]
    v_min_u32 v60, s63, v60
    v_min_u32 v61, s63, v61
    v_min_u32 v62, s63, v62
    v_min_u32 v63, s63, v63
    buffer_store_dwordx4 v[60:63], v67, s[36:39], s57 offen sc1
L_hend:
L_end:
    s_endpgm
.section .rodata,"a"
.p2align 6
.amdhsa_kernel sequential_preLN__gqa_block_cached__glu_gated_reglu__decode_kernel
  .amdhsa_next_free_vgpr 256
  .amdhsa_next_free_sgpr 102
  .amdhsa_accum_offset 256
  .amdhsa_group_segment_fixed_size 0
  .amdhsa_kernarg_size 96
  .amdhsa_user_sgpr_count 2
  .amdhsa_user_sgpr_kernarg_segment_ptr 1
  .amdhsa_system_sgpr_workgroup_id_x 1
.end_amdhsa_kernel
```
